```python
import torch

def _softmax(x, axis=-1):
    return torch.softmax(x, dim=axis)
def _gelu(x):
    return torch.nn.functional.gelu(x, approximate="tanh")
def _silu(x):
    return torch.nn.functional.silu(x)
def _sigmoid(x):
    return torch.sigmoid(x)
def _layernorm(x, axis=-1, eps=1e-5):
    m = x.mean(dim=axis, keepdim=True)
    v = x.var(dim=axis, keepdim=True, unbiased=False)
    return (x - m) / torch.sqrt(v + eps)
def _scatter_add(tgt, idx, src, axis=0):
    return tgt.clone().index_add_(axis, idx, src)
def _segment_sum(src, seg, n):
    out = torch.zeros((n,) + src.shape[1:], dtype=src.dtype)
    return out.index_add_(0, seg, src)
def _pad(x, pw):
    flat = tuple(v for pair in reversed(pw) for v in pair)
    return torch.nn.functional.pad(x, flat)

kernel_name = 'recurrent_scan__sliding_block_cached__mixer_channel_mlp__decode'

def setup_inputs():

    _w = (lambda a: (lambda t: t.to(torch.bfloat16) if t.is_floating_point() else t)(torch.as_tensor(a)))
    def _A_setup():
        B, Sq, D = 4, 1, 512
        Hq, Hkv, Sk, Dh = 32, 8, 4096, 128
        assert Hq % Hkv == 0, (Hq, Hkv)
        return {
            "x": _w((lambda *s: torch.randn(*s, dtype=torch.bfloat16) * 0.1)(B, Sq, D)),
            "k_cache": _w((lambda *s: torch.randn(*s, dtype=torch.bfloat16) * 0.8)(B, Hkv, Sk, Dh)),
            "v_cache": _w((lambda *s: torch.randn(*s, dtype=torch.bfloat16) * 3.2)(B, Hkv, Sk, Dh)),
            "wq": _w((lambda *s: torch.randn(*s, dtype=torch.bfloat16) * 0.8)(D, Hq * Dh) * (D ** -0.5)),
            "wo": _w((lambda *s: torch.randn(*s, dtype=torch.bfloat16) * 3.2)(Hq * Dh, D) * ((Hq * Dh) ** -0.5)),
        }
    _A_in = _A_setup()

    def _B_setup():
        B, S, D, F = 4, 1, 512, 1792
        return {
            "x": _w((lambda *s: torch.randn(*s, dtype=torch.bfloat16) * 0.1)(B, S, D)),
            "w1": _w((lambda *s: torch.randn(*s, dtype=torch.bfloat16) * 3.2)(D, F) * (D ** -0.5)),
            "b1": _w((lambda *s: torch.randn(*s, dtype=torch.bfloat16) * 3.2)(F)),
            "w2": _w((lambda *s: torch.randn(*s, dtype=torch.bfloat16) * 3.2)(F, D) * (F ** -0.5)),
            "b2": _w((lambda *s: torch.randn(*s, dtype=torch.bfloat16) * 3.2)(D)),
        }
    _B_in = _B_setup()

    return {
        "A_x": _A_in["x"],
        "A_k_cache": _A_in["k_cache"],
        "A_v_cache": _A_in["v_cache"],
        "A_wq": _A_in["wq"],
        "A_wo": _A_in["wo"],
        "B_x": _B_in["x"],
        "B_w1": _B_in["w1"],
        "B_b1": _B_in["b1"],
        "B_w2": _B_in["w2"],
        "B_b2": _B_in["b2"],
    }

def reference(A_x, A_k_cache, A_v_cache, A_wq, A_wo, B_x, B_w1, B_b1, B_w2, B_b2):
    def _A_ref(x, k_cache, v_cache, wq, wo):
        B, Sq, D = x.shape
        Hq, Dh = 32, 128
        Hkv, Sk = k_cache.shape[1], k_cache.shape[2]
        W = min(4096, max(256, Sk // 4))
        rep = Hq // Hkv
        q = (lambda x, *d: x.permute(*d))((x @ wq).reshape(B, Sq, Hq, Dh), 0, 2, 1, 3)
        k = (lambda x, n, axis: torch.repeat_interleave(x, n, dim=axis))(k_cache[:, :, Sk - W:, :], rep, axis=1)
        v = (lambda x, n, axis: torch.repeat_interleave(x, n, dim=axis))(v_cache[:, :, Sk - W:, :], rep, axis=1)
        scores = torch.einsum("bhqd,bhkd->bhqk", q, k) * (Dh ** -0.5)
        p = _softmax(scores, axis=-1)
        o = torch.einsum("bhqk,bhkd->bhqd", p, v)
        return (lambda x, *d: x.permute(*d))(o, 0, 2, 1, 3).reshape(B, Sq, Hq * Dh) @ wo

    def _B_ref(x, w1, b1, w2, b2):
        y = _layernorm(x, axis=-1)
        h = _gelu(torch.einsum("bsd,df->bsf", y, w1) + b1)
        return torch.einsum("bsf,fd->bsd", h, w2) + b2

    x = A_x
    xn = _layernorm(x, axis=-1)
    s = _A_ref(xn, A_k_cache, A_v_cache, A_wq, A_wo)
    g = _silu(_B_ref(xn, B_w1, B_b1, B_w2, B_b2))
    return x + s * g
```

```asm
; @launch grid=(256,1,1) block=(576,1,1) lds=138240
.amdgcn_target "amdgcn-amd-amdhsa--gfx950"
.text
.p2align 12
.fill 832, 4, 0xbf810000
.globl recurrent_scan__sliding_block_cached__mixer_channel_mlp__decode_kernel
.p2align 8
.type recurrent_scan__sliding_block_cached__mixer_channel_mlp__decode_kernel,@function
recurrent_scan__sliding_block_cached__mixer_channel_mlp__decode_kernel:
    s_load_dwordx2 s[40:41], s[0:1], 24
    s_load_dwordx16 s[4:19], s[0:1], 0
    s_load_dwordx8 s[20:27], s[0:1], 64
    s_load_dwordx2 s[28:29], s[0:1], 96
    v_lshrrev_b32 v1, 6, v0
    s_cmp_ge_u32 s2, 256
    s_cbranch_scc1 L_end
    v_readfirstlane_b32 s3, v1
    v_and_b32 v0, 63, v0
    s_and_b32 s30, s2, 7
    s_lshr_b32 s31, s2, 6
    s_bfe_u32 s32, s2, 0x30003
    s_lshl3_add_u32 s33, s31, s30
    v_lshlrev_b32 v3, 4, v0
    s_cmp_eq_u32 s3, 0
    s_cbranch_scc0 L_other
    v_lshrrev_b32 v5, 3, v0
    v_and_b32 v6, 6, v5
    v_and_b32 v7, 7, v0
    v_xor_b32 v6, v6, v7
    v_lshlrev_b32 v6, 4, v6
    s_lshl_b32 s38, s32, 7
    s_lshl_b32 s37, s31, 20
    s_lshl_b32 s39, s30, 10
    s_add_u32 s37, s37, s39
    s_add_u32 s37, s37, s38
    v_lshl_add_u32 v10, v5, 13, v6
    v_add_u32 v10, s37, v10
    s_mov_b32 s42, 0x400000
    s_mov_b32 s43, 0x20000
    s_mov_b32 m0, 14848
    s_mov_b32 s36, 0
    s_mov_b32 s37, 0x10000
    s_waitcnt lgkmcnt(0)
L_ld_q:
    buffer_load_dwordx4 v10, s[40:43], s36 offen nt lds
    s_addk_i32 m0, 1024
    s_add_u32 s36, s36, s37
    buffer_load_dwordx4 v10, s[40:43], s36 offen nt lds
    s_addk_i32 m0, 1024
    s_add_u32 s36, s36, s37
    buffer_load_dwordx4 v10, s[40:43], s36 offen nt lds
    s_addk_i32 m0, 1024
    s_add_u32 s36, s36, s37
    buffer_load_dwordx4 v10, s[40:43], s36 offen nt lds
    s_addk_i32 m0, 1024
    s_add_u32 s36, s36, s37
    s_bitcmp1_b32 s36, 20
    s_cbranch_scc0 L_ld_q
    s_branch L_ld_cont
L_other:
    s_sub_u32 s34, s3, 1
    s_and_b32 s34, s34, 3
    v_mov_b32 v1, 1
    v_mov_b32 v2, 0
    v_lshlrev_b32 v134, 2, v0
    s_cmp_ge_u32 s3, 5
    s_cbranch_scc1 L_B0
    s_lshl_b32 s37, s34, 10
    v_add_u32 v4, s37, v3
    s_waitcnt lgkmcnt(0)
    global_load_dwordx4 v[8:11], v4, s[4:5]
    s_load_dword s35, s[28:29], 0
    s_load_dwordx2 s[60:61], s[4:5], 0
    s_branch L_A
L_B0:
    s_cmp_lt_u32 s34, 2
    s_cbranch_scc1 L_B1
    s_getpc_b64 s[38:39]
    s_and_b32 s37, s34, 1
    s_lshl_b32 s37, s37, 13
    v_lshl_add_u32 v7, v0, 7, s37
    v_min_u32 v7, L_end - L_B0 - 128, v7
    global_load_dword v133, v7, s[38:39] offset:128
L_B1:
    s_branch L_B
L_ld_cont:
    s_mov_b64 s[44:45], s[16:17]
    s_cmp_lt_u32 s33, 28
    s_cselect_b32 s46, 0x1c0000, 0
    s_mov_b32 s47, 0x20000
    s_lshl_b32 s37, s32, 6
    v_add_u32 v11, s37, v5
    v_mul_u32_u24 v11, 3584, v11
    s_lshl_b32 s37, s33, 7
    v_add3_u32 v11, v11, v6, s37
    s_addk_i32 m0, 0
    s_mov_b32 s36, 0
    buffer_load_dwordx4 v11, s[44:47], s36 offen nt lds
    s_addk_i32 m0, 1024
    s_mov_b32 s36, 28672
    buffer_load_dwordx4 v11, s[44:47], s36 offen nt lds
    s_addk_i32 m0, 1024
    s_mov_b32 s36, 57344
    buffer_load_dwordx4 v11, s[44:47], s36 offen nt lds
    s_addk_i32 m0, 1024
    s_mov_b32 s36, 86016
    buffer_load_dwordx4 v11, s[44:47], s36 offen nt lds
    s_addk_i32 m0, 1024
    s_mov_b32 s36, 114688
    buffer_load_dwordx4 v11, s[44:47], s36 offen nt lds
    s_addk_i32 m0, 1024
    s_mov_b32 s36, 143360
    buffer_load_dwordx4 v11, s[44:47], s36 offen nt lds
    s_addk_i32 m0, 1024
    s_mov_b32 s36, 172032
    v_mov_b32 v20, 0
    v_mov_b32 v21, 0
    v_mov_b32 v22, 0
    v_mov_b32 v23, 0
    v_lshlrev_b32 v16, 2, v0
    ds_write_b128 v3, v[20:23]
    ds_write_b128 v3, v[20:23] offset:1024
    ds_write_b128 v3, v[20:23] offset:2048
    s_waitcnt lgkmcnt(0)
    s_barrier
    s_waitcnt vmcnt(21)
    buffer_load_dwordx4 v11, s[44:47], s36 offen nt lds
    s_addk_i32 m0, 1024
    s_mov_b32 s36, 200704
    s_waitcnt vmcnt(21)
    buffer_load_dwordx4 v11, s[44:47], s36 offen nt lds
    s_mov_b64 s[48:49], s[6:7]
    s_mov_b32 s50, 0x2000000
    s_mov_b32 s51, 0x20000
    s_lshl_b32 s37, s33, 20
    s_lshl_b32 s39, s32, 15
    s_add_u32 s37, s37, s39
    s_add_u32 s37, s37, 786432
    v_lshrrev_b32 v7, 4, v0
    v_and_b32 v8, 15, v0
    v_lshlrev_b32 v9, 2, v7
    v_xor_b32 v9, v9, v8
    v_lshlrev_b32 v9, 4, v9
    v_lshl_add_u32 v9, v7, 8, v9
    v_add_u32 v12, s37, v9
    v_lshlrev_b32 v9, 1, v7
    v_xor_b32 v9, v9, v8
    v_lshlrev_b32 v9, 4, v9
    v_lshl_add_u32 v9, v7, 8, v9
    v_add_u32 v13, s37, v9
    s_lshl2_add_u32 s35, s30, s31
    s_lshl_b32 s35, s35, 10
    s_addk_i32 m0, 29696
    s_add_u32 s36, s35, 0
    s_and_b32 s36, s36, 0x7fff
    s_waitcnt vmcnt(21)
    buffer_load_dwordx4 v12, s[48:51], s36 offen nt lds
    s_addk_i32 m0, 1040
    s_add_u32 s36, s35, 4096
    s_and_b32 s36, s36, 0x7fff
    s_waitcnt vmcnt(21)
    buffer_load_dwordx4 v12, s[48:51], s36 offen nt lds
    s_addk_i32 m0, 1040
    s_add_u32 s36, s35, 8192
    s_and_b32 s36, s36, 0x7fff
    s_waitcnt vmcnt(21)
    buffer_load_dwordx4 v12, s[48:51], s36 offen nt lds
    s_addk_i32 m0, 1040
    s_add_u32 s36, s35, 12288
    s_and_b32 s36, s36, 0x7fff
    s_waitcnt vmcnt(21)
    buffer_load_dwordx4 v12, s[48:51], s36 offen nt lds
    s_addk_i32 m0, 1040
    s_add_u32 s36, s35, 16384
    s_and_b32 s36, s36, 0x7fff
    s_waitcnt vmcnt(21)
    buffer_load_dwordx4 v12, s[48:51], s36 offen nt lds
    s_addk_i32 m0, 1040
    s_add_u32 s36, s35, 20480
    s_and_b32 s36, s36, 0x7fff
    v_mov_b32 v4, 8
    s_waitcnt vmcnt(21)
    buffer_load_dwordx4 v12, s[48:51], s36 offen nt lds
    ds_write_b32 v16, v4 offset:0
    s_addk_i32 m0, 1040
    s_add_u32 s36, s35, 24576
    s_and_b32 s36, s36, 0x7fff
    s_waitcnt vmcnt(21)
    buffer_load_dwordx4 v12, s[48:51], s36 offen nt lds
    s_addk_i32 m0, 1040
    s_add_u32 s36, s35, 28672
    s_and_b32 s36, s36, 0x7fff
    s_waitcnt vmcnt(21)
    buffer_load_dwordx4 v12, s[48:51], s36 offen nt lds
    s_addk_i32 m0, 1040
    s_add_u32 s36, s35, 1024
    s_and_b32 s36, s36, 0x7fff
    s_waitcnt vmcnt(21)
    buffer_load_dwordx4 v12, s[48:51], s36 offen nt lds
    s_addk_i32 m0, 1040
    s_add_u32 s36, s35, 5120
    s_and_b32 s36, s36, 0x7fff
    s_waitcnt vmcnt(21)
    buffer_load_dwordx4 v12, s[48:51], s36 offen nt lds
    s_addk_i32 m0, 1040
    s_add_u32 s36, s35, 9216
    s_and_b32 s36, s36, 0x7fff
    s_waitcnt vmcnt(21)
    buffer_load_dwordx4 v12, s[48:51], s36 offen nt lds
    s_addk_i32 m0, 1040
    s_add_u32 s36, s35, 13312
    s_and_b32 s36, s36, 0x7fff
    s_waitcnt vmcnt(21)
    buffer_load_dwordx4 v12, s[48:51], s36 offen nt lds
    s_addk_i32 m0, 1040
    s_add_u32 s36, s35, 17408
    s_and_b32 s36, s36, 0x7fff
    s_waitcnt vmcnt(21)
    buffer_load_dwordx4 v12, s[48:51], s36 offen nt lds
    s_addk_i32 m0, 1040
    s_add_u32 s36, s35, 21504
    s_and_b32 s36, s36, 0x7fff
    v_mov_b32 v4, 16
    s_waitcnt vmcnt(21)
    buffer_load_dwordx4 v12, s[48:51], s36 offen nt lds
    ds_write_b32 v16, v4 offset:0
    s_addk_i32 m0, 1040
    s_add_u32 s36, s35, 25600
    s_and_b32 s36, s36, 0x7fff
    s_waitcnt vmcnt(21)
    buffer_load_dwordx4 v12, s[48:51], s36 offen nt lds
    s_addk_i32 m0, 1040
    s_add_u32 s36, s35, 29696
    s_and_b32 s36, s36, 0x7fff
    s_waitcnt vmcnt(21)
    buffer_load_dwordx4 v12, s[48:51], s36 offen nt lds
    s_addk_i32 m0, 1040
    s_add_u32 s36, s35, 2048
    s_and_b32 s36, s36, 0x7fff
    s_waitcnt vmcnt(21)
    buffer_load_dwordx4 v12, s[48:51], s36 offen nt lds
    s_addk_i32 m0, 1040
    s_add_u32 s36, s35, 6144
    s_and_b32 s36, s36, 0x7fff
    s_waitcnt vmcnt(21)
    buffer_load_dwordx4 v12, s[48:51], s36 offen nt lds
    s_addk_i32 m0, 1040
    s_add_u32 s36, s35, 10240
    s_and_b32 s36, s36, 0x7fff
    s_waitcnt vmcnt(21)
    buffer_load_dwordx4 v12, s[48:51], s36 offen nt lds
    s_addk_i32 m0, 1040
    s_add_u32 s36, s35, 14336
    s_and_b32 s36, s36, 0x7fff
    s_waitcnt vmcnt(21)
    buffer_load_dwordx4 v12, s[48:51], s36 offen nt lds
    s_addk_i32 m0, 1040
    s_add_u32 s36, s35, 18432
    s_and_b32 s36, s36, 0x7fff
    s_waitcnt vmcnt(21)
    buffer_load_dwordx4 v12, s[48:51], s36 offen nt lds
    s_addk_i32 m0, 1040
    s_add_u32 s36, s35, 22528
    s_and_b32 s36, s36, 0x7fff
    v_mov_b32 v4, 24
    s_waitcnt vmcnt(21)
    buffer_load_dwordx4 v12, s[48:51], s36 offen nt lds
    ds_write_b32 v16, v4 offset:0
    s_addk_i32 m0, 1040
    s_add_u32 s36, s35, 26624
    s_and_b32 s36, s36, 0x7fff
    s_waitcnt vmcnt(21)
    buffer_load_dwordx4 v12, s[48:51], s36 offen nt lds
    s_addk_i32 m0, 1040
    s_add_u32 s36, s35, 30720
    s_and_b32 s36, s36, 0x7fff
    s_waitcnt vmcnt(21)
    buffer_load_dwordx4 v12, s[48:51], s36 offen nt lds
    s_addk_i32 m0, 1040
    s_add_u32 s36, s35, 3072
    s_and_b32 s36, s36, 0x7fff
    s_waitcnt vmcnt(21)
    buffer_load_dwordx4 v12, s[48:51], s36 offen nt lds
    s_addk_i32 m0, 1040
    s_add_u32 s36, s35, 7168
    s_and_b32 s36, s36, 0x7fff
    s_waitcnt vmcnt(21)
    buffer_load_dwordx4 v12, s[48:51], s36 offen nt lds
    s_addk_i32 m0, 1040
    s_add_u32 s36, s35, 11264
    s_and_b32 s36, s36, 0x7fff
    s_waitcnt vmcnt(21)
    buffer_load_dwordx4 v12, s[48:51], s36 offen nt lds
    s_addk_i32 m0, 1040
    s_add_u32 s36, s35, 15360
    s_and_b32 s36, s36, 0x7fff
    s_waitcnt vmcnt(21)
    buffer_load_dwordx4 v12, s[48:51], s36 offen nt lds
    s_addk_i32 m0, 1040
    s_add_u32 s36, s35, 19456
    s_and_b32 s36, s36, 0x7fff
    s_waitcnt vmcnt(21)
    buffer_load_dwordx4 v12, s[48:51], s36 offen nt lds
    s_addk_i32 m0, 1040
    s_add_u32 s36, s35, 23552
    s_and_b32 s36, s36, 0x7fff
    v_mov_b32 v4, 32
    s_waitcnt vmcnt(21)
    buffer_load_dwordx4 v12, s[48:51], s36 offen nt lds
    ds_write_b32 v16, v4 offset:0
    s_addk_i32 m0, 1040
    s_add_u32 s36, s35, 27648
    s_and_b32 s36, s36, 0x7fff
    s_waitcnt vmcnt(21)
    buffer_load_dwordx4 v12, s[48:51], s36 offen nt lds
    s_addk_i32 m0, 1040
    s_add_u32 s36, s35, 31744
    s_and_b32 s36, s36, 0x7fff
    s_waitcnt vmcnt(21)
    buffer_load_dwordx4 v12, s[48:51], s36 offen nt lds
    s_mov_b64 s[56:57], s[20:21]
    s_mov_b32 s58, 0x1c0000
    s_mov_b32 s59, 0x20000
    s_lshl_b32 s37, s33, 16
    s_xor_b32 s39, s38, 768
    s_add_u32 s37, s37, s39
    v_lshl_add_u32 v14, v5, 10, v6
    v_add_u32 v14, s37, v14
    s_mov_b32 m0, 39424
    s_mov_b32 s36, 0
    s_waitcnt vmcnt(21)
    buffer_load_dwordx4 v14, s[56:59], s36 offen nt lds
    s_addk_i32 m0, 1024
    s_mov_b32 s36, 8192
    s_waitcnt vmcnt(21)
    buffer_load_dwordx4 v14, s[56:59], s36 offen nt lds
    s_addk_i32 m0, 1024
    s_mov_b32 s36, 16384
    s_waitcnt vmcnt(21)
    buffer_load_dwordx4 v14, s[56:59], s36 offen nt lds
    s_addk_i32 m0, 1024
    s_mov_b32 s36, 24576
    s_waitcnt vmcnt(21)
    buffer_load_dwordx4 v14, s[56:59], s36 offen nt lds
    s_addk_i32 m0, 1024
    s_mov_b32 s36, 32768
    s_waitcnt vmcnt(21)
    buffer_load_dwordx4 v14, s[56:59], s36 offen nt lds
    s_addk_i32 m0, 1024
    s_mov_b32 s36, 40960
    v_mov_b32 v4, 40
    s_waitcnt vmcnt(21)
    buffer_load_dwordx4 v14, s[56:59], s36 offen nt lds
    ds_write_b32 v16, v4 offset:0
    s_addk_i32 m0, 1024
    s_mov_b32 s36, 49152
    s_waitcnt vmcnt(21)
    buffer_load_dwordx4 v14, s[56:59], s36 offen nt lds
    s_addk_i32 m0, 1024
    s_mov_b32 s36, 57344
    s_waitcnt vmcnt(21)
    buffer_load_dwordx4 v14, s[56:59], s36 offen nt lds
    s_mov_b64 s[52:53], s[8:9]
    s_mov_b32 s54, 0x2000000
    s_mov_b32 s55, 0x20000
    s_mov_b32 m0, 101376
    s_add_u32 s36, s35, 0
    s_and_b32 s36, s36, 0x7fff
    s_waitcnt vmcnt(21)
    buffer_load_dwordx4 v13, s[52:55], s36 offen nt lds
    s_addk_i32 m0, 1152
    s_add_u32 s36, s35, 4096
    s_and_b32 s36, s36, 0x7fff
    s_waitcnt vmcnt(21)
    buffer_load_dwordx4 v13, s[52:55], s36 offen nt lds
    s_addk_i32 m0, 1152
    s_add_u32 s36, s35, 8192
    s_and_b32 s36, s36, 0x7fff
    s_waitcnt vmcnt(21)
    buffer_load_dwordx4 v13, s[52:55], s36 offen nt lds
    s_addk_i32 m0, 1152
    s_add_u32 s36, s35, 12288
    s_and_b32 s36, s36, 0x7fff
    s_waitcnt vmcnt(21)
    buffer_load_dwordx4 v13, s[52:55], s36 offen nt lds
    s_addk_i32 m0, 1152
    s_add_u32 s36, s35, 16384
    s_and_b32 s36, s36, 0x7fff
    s_waitcnt vmcnt(21)
    buffer_load_dwordx4 v13, s[52:55], s36 offen nt lds
    s_addk_i32 m0, 1152
    s_add_u32 s36, s35, 20480
    s_and_b32 s36, s36, 0x7fff
    v_mov_b32 v4, 48
    s_waitcnt vmcnt(21)
    buffer_load_dwordx4 v13, s[52:55], s36 offen nt lds
    ds_write_b32 v16, v4 offset:0
    s_addk_i32 m0, 1152
    s_add_u32 s36, s35, 24576
    s_and_b32 s36, s36, 0x7fff
    s_waitcnt vmcnt(21)
    buffer_load_dwordx4 v13, s[52:55], s36 offen nt lds
    s_addk_i32 m0, 1152
    s_add_u32 s36, s35, 28672
    s_and_b32 s36, s36, 0x7fff
    s_waitcnt vmcnt(21)
    buffer_load_dwordx4 v13, s[52:55], s36 offen nt lds
    s_addk_i32 m0, 1152
    s_add_u32 s36, s35, 1024
    s_and_b32 s36, s36, 0x7fff
    s_waitcnt vmcnt(21)
    buffer_load_dwordx4 v13, s[52:55], s36 offen nt lds
    s_addk_i32 m0, 1152
    s_add_u32 s36, s35, 5120
    s_and_b32 s36, s36, 0x7fff
    v_mov_b32 v4, 52
    s_waitcnt vmcnt(21)
    buffer_load_dwordx4 v13, s[52:55], s36 offen nt lds
    ds_write_b32 v16, v4 offset:0
    s_addk_i32 m0, 1152
    s_add_u32 s36, s35, 9216
    s_and_b32 s36, s36, 0x7fff
    s_waitcnt vmcnt(21)
    buffer_load_dwordx4 v13, s[52:55], s36 offen nt lds
    s_addk_i32 m0, 1152
    s_add_u32 s36, s35, 13312
    s_and_b32 s36, s36, 0x7fff
    s_waitcnt vmcnt(21)
    buffer_load_dwordx4 v13, s[52:55], s36 offen nt lds
    s_addk_i32 m0, 1152
    s_add_u32 s36, s35, 17408
    s_and_b32 s36, s36, 0x7fff
    s_waitcnt vmcnt(21)
    buffer_load_dwordx4 v13, s[52:55], s36 offen nt lds
    s_addk_i32 m0, 1152
    s_add_u32 s36, s35, 21504
    s_and_b32 s36, s36, 0x7fff
    v_mov_b32 v4, 56
    s_waitcnt vmcnt(21)
    buffer_load_dwordx4 v13, s[52:55], s36 offen nt lds
    ds_write_b32 v16, v4 offset:0
    s_addk_i32 m0, 1152
    s_add_u32 s36, s35, 25600
    s_and_b32 s36, s36, 0x7fff
    s_waitcnt vmcnt(21)
    buffer_load_dwordx4 v13, s[52:55], s36 offen nt lds
    s_addk_i32 m0, 1152
    s_add_u32 s36, s35, 29696
    s_and_b32 s36, s36, 0x7fff
    s_waitcnt vmcnt(21)
    buffer_load_dwordx4 v13, s[52:55], s36 offen nt lds
    s_addk_i32 m0, 1152
    s_add_u32 s36, s35, 2048
    s_and_b32 s36, s36, 0x7fff
    s_waitcnt vmcnt(21)
    buffer_load_dwordx4 v13, s[52:55], s36 offen nt lds
    s_addk_i32 m0, 1152
    s_add_u32 s36, s35, 6144
    s_and_b32 s36, s36, 0x7fff
    s_waitcnt vmcnt(21)
    buffer_load_dwordx4 v13, s[52:55], s36 offen nt lds
    s_addk_i32 m0, 1152
    s_add_u32 s36, s35, 10240
    s_and_b32 s36, s36, 0x7fff
    s_waitcnt vmcnt(21)
    buffer_load_dwordx4 v13, s[52:55], s36 offen nt lds
    s_addk_i32 m0, 1152
    s_add_u32 s36, s35, 14336
    s_and_b32 s36, s36, 0x7fff
    s_waitcnt vmcnt(21)
    buffer_load_dwordx4 v13, s[52:55], s36 offen nt lds
    s_addk_i32 m0, 1152
    s_add_u32 s36, s35, 18432
    s_and_b32 s36, s36, 0x7fff
    s_waitcnt vmcnt(21)
    buffer_load_dwordx4 v13, s[52:55], s36 offen nt lds
    s_addk_i32 m0, 1152
    s_add_u32 s36, s35, 22528
    s_and_b32 s36, s36, 0x7fff
    v_mov_b32 v4, 64
    s_waitcnt vmcnt(21)
    buffer_load_dwordx4 v13, s[52:55], s36 offen nt lds
    ds_write_b32 v16, v4 offset:0
    s_addk_i32 m0, 1152
    s_add_u32 s36, s35, 26624
    s_and_b32 s36, s36, 0x7fff
    s_waitcnt vmcnt(21)
    buffer_load_dwordx4 v13, s[52:55], s36 offen nt lds
    s_addk_i32 m0, 1152
    s_add_u32 s36, s35, 30720
    s_and_b32 s36, s36, 0x7fff
    s_waitcnt vmcnt(21)
    buffer_load_dwordx4 v13, s[52:55], s36 offen nt lds
    s_addk_i32 m0, 1152
    s_add_u32 s36, s35, 3072
    s_and_b32 s36, s36, 0x7fff
    s_waitcnt vmcnt(21)
    buffer_load_dwordx4 v13, s[52:55], s36 offen nt lds
    s_addk_i32 m0, 1152
    s_add_u32 s36, s35, 7168
    s_and_b32 s36, s36, 0x7fff
    s_waitcnt vmcnt(21)
    buffer_load_dwordx4 v13, s[52:55], s36 offen nt lds
    s_addk_i32 m0, 1152
    s_add_u32 s36, s35, 11264
    s_and_b32 s36, s36, 0x7fff
    s_waitcnt vmcnt(21)
    buffer_load_dwordx4 v13, s[52:55], s36 offen nt lds
    s_addk_i32 m0, 1152
    s_add_u32 s36, s35, 15360
    s_and_b32 s36, s36, 0x7fff
    s_waitcnt vmcnt(21)
    buffer_load_dwordx4 v13, s[52:55], s36 offen nt lds
    s_addk_i32 m0, 1152
    s_add_u32 s36, s35, 19456
    s_and_b32 s36, s36, 0x7fff
    s_waitcnt vmcnt(21)
    buffer_load_dwordx4 v13, s[52:55], s36 offen nt lds
    s_addk_i32 m0, 1152
    s_add_u32 s36, s35, 23552
    s_and_b32 s36, s36, 0x7fff
    s_waitcnt vmcnt(21)
    buffer_load_dwordx4 v13, s[52:55], s36 offen nt lds
    s_addk_i32 m0, 1152
    s_add_u32 s36, s35, 27648
    s_and_b32 s36, s36, 0x7fff
    s_waitcnt vmcnt(21)
    buffer_load_dwordx4 v13, s[52:55], s36 offen nt lds
    s_addk_i32 m0, 1152
    s_add_u32 s36, s35, 31744
    s_and_b32 s36, s36, 0x7fff
    s_waitcnt vmcnt(21)
    buffer_load_dwordx4 v13, s[52:55], s36 offen nt lds
    s_mov_b64 s[60:61], s[12:13]
    s_mov_b32 s62, 0x400000
    s_mov_b32 s63, 0x20000
    v_lshrrev_b32 v7, 2, v5
    v_and_b32 v8, 1, v5
    v_lshl_add_u32 v7, v8, 4, v7
    v_bfe_u32 v8, v5, 1, 1
    v_lshl_add_u32 v7, v8, 3, v7
    v_lshl_add_u32 v15, v7, 10, v6
    s_lshl2_add_u32 s37, s30, s31
    s_lshl_b32 s37, s37, 17
    s_xor_b32 s39, s38, 640
    s_add_u32 s37, s37, s39
    v_add_u32 v15, s37, v15
    s_mov_b32 m0, 47616
    s_mov_b32 s36, 0
    s_waitcnt vmcnt(21)
    buffer_load_dwordx4 v15, s[60:63], s36 offen nt lds
    s_addk_i32 m0, 1024
    s_mov_b32 s36, 2048
    s_waitcnt vmcnt(21)
    buffer_load_dwordx4 v15, s[60:63], s36 offen nt lds
    s_addk_i32 m0, 1024
    s_mov_b32 s36, 4096
    s_waitcnt vmcnt(21)
    buffer_load_dwordx4 v15, s[60:63], s36 offen nt lds
    s_addk_i32 m0, 1024
    s_mov_b32 s36, 6144
    s_waitcnt vmcnt(21)
    buffer_load_dwordx4 v15, s[60:63], s36 offen nt lds
    s_addk_i32 m0, 1024
    s_mov_b32 s36, 32768
    s_waitcnt vmcnt(21)
    buffer_load_dwordx4 v15, s[60:63], s36 offen nt lds
    s_addk_i32 m0, 1024
    s_mov_b32 s36, 34816
    v_mov_b32 v4, 80
    s_waitcnt vmcnt(21)
    buffer_load_dwordx4 v15, s[60:63], s36 offen nt lds
    ds_write_b32 v16, v4 offset:0
    s_addk_i32 m0, 1024
    s_mov_b32 s36, 36864
    s_waitcnt vmcnt(21)
    buffer_load_dwordx4 v15, s[60:63], s36 offen nt lds
    s_addk_i32 m0, 1024
    s_mov_b32 s36, 38912
    s_waitcnt vmcnt(21)
    buffer_load_dwordx4 v15, s[60:63], s36 offen nt lds
    s_addk_i32 m0, 1024
    s_mov_b32 s36, 65536
    s_waitcnt vmcnt(21)
    buffer_load_dwordx4 v15, s[60:63], s36 offen nt lds
    s_addk_i32 m0, 1024
    s_mov_b32 s36, 67584
    s_waitcnt vmcnt(21)
    buffer_load_dwordx4 v15, s[60:63], s36 offen nt lds
    s_addk_i32 m0, 1024
    s_mov_b32 s36, 69632
    s_waitcnt vmcnt(21)
    buffer_load_dwordx4 v15, s[60:63], s36 offen nt lds
    s_addk_i32 m0, 1024
    s_mov_b32 s36, 71680
    s_waitcnt vmcnt(21)
    buffer_load_dwordx4 v15, s[60:63], s36 offen nt lds
    s_addk_i32 m0, 1024
    s_mov_b32 s36, 98304
    s_waitcnt vmcnt(21)
    buffer_load_dwordx4 v15, s[60:63], s36 offen nt lds
    s_addk_i32 m0, 1024
    s_mov_b32 s36, 100352
    v_mov_b32 v4, 88
    s_waitcnt vmcnt(21)
    buffer_load_dwordx4 v15, s[60:63], s36 offen nt lds
    ds_write_b32 v16, v4 offset:0
    s_addk_i32 m0, 1024
    s_mov_b32 s36, 102400
    s_waitcnt vmcnt(21)
    buffer_load_dwordx4 v15, s[60:63], s36 offen nt lds
    s_addk_i32 m0, 1024
    s_mov_b32 s36, 104448
    s_waitcnt vmcnt(21)
    buffer_load_dwordx4 v15, s[60:63], s36 offen nt lds
    v_mov_b32 v4, 96
    s_waitcnt vmcnt(16)
    ds_write_b32 v16, v4 offset:0
    v_mov_b32 v4, 112
    s_waitcnt vmcnt(0)
    ds_write_b32 v16, v4 offset:0
    s_branch L_fin
L_A:
    s_barrier
    s_mov_b32 s44, 0x07060500
    s_mov_b32 s45, 0x07060501
    s_mov_b32 s46, 0x07060502
    s_mov_b32 s47, 0x07060503
    s_mov_b32 s48, 0x0c0c0400
    s_mov_b32 s49, 0x04000c0c
    s_mov_b32 s12, 0x000f000f
    s_mov_b32 s13, s12
    s_mov_b32 s36, 0x200000
    s_mul_i32 s37, s34, 1088
    v_add_u32 v4, s37, v3
    v_and_b32 v40, 15, v0
    v_lshrrev_b32 v41, 4, v0
    v_lshlrev_b32 v42, 4, v40
    v_lshl_add_u32 v42, v41, 11, v42
    s_lshl_b32 s37, s30, 15
    s_lshl_b32 s38, s34, 13
    s_add_u32 s37, s37, s38
    s_lshl_b32 s38, s31, 8
    s_add_u32 s37, s37, s38
    s_add_u32 s37, s37, 262144
    v_add_u32 v64, s37, v42
    s_lshl_b32 s39, s33, 13
    s_lshl_b32 s38, s34, 8
    s_add_u32 s39, s39, s38
    s_add_u32 s39, s39, 524288
    s_cmp_ge_u32 s33, 28
    s_cselect_b32 s37, s37, s39
    v_add_u32 v65, s37, v42
    v_lshrrev_b32 v5, 1, v41
    v_and_b32 v6, 1, v41
    v_lshl_add_u32 v66, v6, 4, v40
    v_lshl_add_u32 v66, v5, 6, v66
    s_mul_i32 s37, s34, 272
    v_lshl_add_u32 v66, v66, 1, s37
    v_lshl_add_u32 v43, v6, 1, v5
    v_lshl_add_u32 v67, v43, 4, v40
    v_lshlrev_b32 v67, 1, v67
    s_min_u32 s39, s33, 27
    s_lshl_b32 s37, s39, 7
    v_add_u32 v5, s37, v67
    global_load_ushort v45, v5, s[18:19]
    s_mul_i32 s37, s34, 144
    v_add_u32 v67, s37, v67
    v_and_b32 v5, 1, v41
    v_lshlrev_b32 v5, 9, v5
    v_xor_b32 v64, v64, v5
    v_xor_b32 v71, 0x100, v64
    s_lshr_b32 s37, s2, 3
    s_lshl_b32 s38, s37, 5
    s_lshl_b32 s39, s30, 15
    s_add_u32 s38, s38, s39
    v_and_b32 v5, 1, v0
    v_lshl_add_u32 v6, v5, 4, s38
    v_lshrrev_b32 v7, 1, v0
    v_lshl_add_u32 v73, v7, 10, v6
    v_add_u32 v73, 1572864, v73
    v_min_u32 v7, 27, v7
    v_lshl_add_u32 v72, v7, 10, v6
    v_add_u32 v72, 1310720, v72
    s_lshr_b32 s38, s37, 1
    s_lshl_b32 s38, s38, 3
    s_lshl_b32 s39, s30, 7
    s_add_u32 s38, s38, s39
    v_lshl_add_u32 v74, v43, 1, s38
    s_and_b32 s38, s37, 1
    s_lshl_b32 s38, s38, 11
    v_lshl_add_u32 v75, v5, 10, s38
    v_add_u32 v75, v75, v74
    s_mov_b32 s52, 0
    s_cmp_eq_u32 s34, 3
    s_cbranch_scc0 L_A_nf
    global_load_ushort v76, v74, s[22:23]
    global_load_ushort v77, v75, s[4:5]
    global_load_ushort v78, v75, s[24:25]
    s_waitcnt vmcnt(4)
    s_branch L_A_ln
L_A_nf:
    s_waitcnt vmcnt(1)
L_A_ln:
    v_lshlrev_b32 v12, 16, v8
    v_and_b32 v13, 0xffff0000, v8
    v_lshlrev_b32 v14, 16, v9
    v_and_b32 v15, 0xffff0000, v9
    v_lshlrev_b32 v16, 16, v10
    v_and_b32 v17, 0xffff0000, v10
    v_lshlrev_b32 v18, 16, v11
    v_and_b32 v19, 0xffff0000, v11
    v_pk_add_f32 v[28:29], v[12:13], v[14:15]
    v_pk_add_f32 v[30:31], v[16:17], v[18:19]
    v_pk_add_f32 v[28:29], v[28:29], v[30:31]
    v_add_f32 v28, v28, v29
    s_nop 1
    v_add_f32_dpp v28, v28, v28 row_ror:8 row_mask:0xf bank_mask:0xf
    s_nop 1
    v_add_f32_dpp v28, v28, v28 row_ror:4 row_mask:0xf bank_mask:0xf
    s_nop 1
    v_add_f32_dpp v28, v28, v28 row_ror:2 row_mask:0xf bank_mask:0xf
    s_nop 1
    v_add_f32_dpp v28, v28, v28 row_ror:1 row_mask:0xf bank_mask:0xf
    v_mov_b32 v29, v28
    s_nop 1
    v_permlane16_swap_b32 v28, v29
    v_add_f32 v28, v28, v29
    v_mov_b32 v29, v28
    s_nop 1
    v_permlane32_swap_b32 v28, v29
    v_add_f32 v28, v28, v29
    v_mul_f32 v28, 0x3b000000, v28
    v_pk_add_f32 v[20:21], v[12:13], v[28:29] op_sel:[0,0] op_sel_hi:[1,0] neg_lo:[0,1] neg_hi:[0,1]
    v_pk_add_f32 v[22:23], v[14:15], v[28:29] op_sel:[0,0] op_sel_hi:[1,0] neg_lo:[0,1] neg_hi:[0,1]
    v_pk_add_f32 v[24:25], v[16:17], v[28:29] op_sel:[0,0] op_sel_hi:[1,0] neg_lo:[0,1] neg_hi:[0,1]
    v_pk_add_f32 v[26:27], v[18:19], v[28:29] op_sel:[0,0] op_sel_hi:[1,0] neg_lo:[0,1] neg_hi:[0,1]
    v_pk_mul_f32 v[30:31], v[20:21], v[20:21]
    v_pk_fma_f32 v[30:31], v[22:23], v[22:23], v[30:31]
    v_pk_fma_f32 v[30:31], v[24:25], v[24:25], v[30:31]
    v_pk_fma_f32 v[30:31], v[26:27], v[26:27], v[30:31]
    v_add_f32 v30, v30, v31
    v_cvt_pk_bf16_f32 v28, v28, v28
    v_lshlrev_b32 v28, 16, v28
    v_add_f32_dpp v30, v30, v30 row_ror:8 row_mask:0xf bank_mask:0xf
    s_nop 1
    v_add_f32_dpp v30, v30, v30 row_ror:4 row_mask:0xf bank_mask:0xf
    s_nop 1
    v_add_f32_dpp v30, v30, v30 row_ror:2 row_mask:0xf bank_mask:0xf
    s_nop 1
    v_add_f32_dpp v30, v30, v30 row_ror:1 row_mask:0xf bank_mask:0xf
    v_mov_b32 v29, v30
    s_nop 1
    v_permlane16_swap_b32 v30, v29
    v_add_f32 v30, v30, v29
    v_mov_b32 v29, v30
    s_nop 1
    v_permlane32_swap_b32 v30, v29
    v_add_f32 v30, v30, v29
    v_mul_f32 v30, 0x3b000000, v30
    v_pk_add_f32 v[20:21], v[12:13], v[28:29] op_sel:[0,0] op_sel_hi:[1,0] neg_lo:[0,1] neg_hi:[0,1]
    v_pk_add_f32 v[22:23], v[14:15], v[28:29] op_sel:[0,0] op_sel_hi:[1,0] neg_lo:[0,1] neg_hi:[0,1]
    v_pk_add_f32 v[24:25], v[16:17], v[28:29] op_sel:[0,0] op_sel_hi:[1,0] neg_lo:[0,1] neg_hi:[0,1]
    v_pk_add_f32 v[26:27], v[18:19], v[28:29] op_sel:[0,0] op_sel_hi:[1,0] neg_lo:[0,1] neg_hi:[0,1]
    v_cvt_pk_bf16_f32 v30, v30, v30
    v_lshlrev_b32 v30, 16, v30
    v_add_f32 v30, 0x3727c5ac, v30
    v_cvt_pk_bf16_f32 v30, v30, v30
    v_lshlrev_b32 v30, 16, v30
    v_sqrt_f32 v30, v30
    v_cvt_pk_bf16_f32 v8, v20, v21
    v_cvt_pk_bf16_f32 v9, v22, v23
    v_cvt_pk_bf16_f32 v10, v24, v25
    v_cvt_pk_bf16_f32 v11, v26, v27
    v_cvt_pk_bf16_f32 v30, v30, v30
    v_lshlrev_b32 v30, 16, v30
    v_rcp_f32 v30, v30
    v_lshlrev_b32 v12, 16, v8
    v_and_b32 v13, 0xffff0000, v8
    v_lshlrev_b32 v14, 16, v9
    v_and_b32 v15, 0xffff0000, v9
    v_lshlrev_b32 v16, 16, v10
    v_and_b32 v17, 0xffff0000, v10
    v_lshlrev_b32 v18, 16, v11
    v_and_b32 v19, 0xffff0000, v11
    v_pk_mul_f32 v[12:13], v[30:31], v[12:13] op_sel:[0,0] op_sel_hi:[0,1]
    v_pk_mul_f32 v[14:15], v[30:31], v[14:15] op_sel:[0,0] op_sel_hi:[0,1]
    v_pk_mul_f32 v[16:17], v[30:31], v[16:17] op_sel:[0,0] op_sel_hi:[0,1]
    v_pk_mul_f32 v[18:19], v[30:31], v[18:19] op_sel:[0,0] op_sel_hi:[0,1]
    v_cvt_pk_bf16_f32 v8, v12, v13
    v_cvt_pk_bf16_f32 v9, v14, v15
    v_cvt_pk_bf16_f32 v10, v16, v17
    v_cvt_pk_bf16_f32 v11, v18, v19
    ds_write_b128 v4, v[8:11] offset:5952
    s_cmp_eq_u32 s52, 0
    s_cbranch_scc0 L_A_ln2
    s_waitcnt lgkmcnt(0)
    s_mul_i32 s35, s35, 0x9E3779B1
    s_add_u32 s62, s35, 0x7F4A7C15
    s_mul_i32 s60, s60, 0x85EBCA6B
    s_add_u32 s60, s60, s61
    s_xor_b32 s35, s62, s60
    v_mov_b32 v47, s35
    ds_write_b32 v134, v47 offset:2560
    ds_add_u32 v134, v1 offset:256
    v_add_u32 v4, 4352, v4
    s_mov_b32 s52, 1
    s_branch L_A_ln
L_A_ln2:
    ds_add_u32 v134, v1 offset:512
    v_lshrrev_b32 v5, 2, v0
    v_bfe_u32 v6, v0, 3, 2
    v_xor_b32 v6, s34, v6
    v_lshlrev_b32 v6, 5, v6
    v_lshl_add_u32 v5, v5, 7, v6
    v_and_b32 v6, 3, v0
    v_lshl_add_u32 v68, v6, 3, v5
    v_mul_u32_u24 v69, 144, v6
    v_lshl_add_u32 v69, v41, 3, v69
    v_add_u32 v69, 4288, v69
    v_lshlrev_b32 v70, 4, v6
    v_lshl_add_u32 v70, v41, 6, v70
    s_xor_b32 s37, s32, 6
    s_lshl_b32 s37, s37, 5
    s_add_u32 s37, s37, s33
    s_lshl2_add_u32 s37, s37, s34
    s_lshl_b32 s37, s37, 8
    s_add_u32 s37, s37, 1310720
    v_add_u32 v70, s37, v70
    s_andn2_b32 s37, s2, 7
    s_lshl_b32 s37, s37, 8
    s_and_b32 s38, s30, 1
    s_lshl_b32 s38, s38, 7
    s_add_u32 s37, s37, s38
    s_lshr_b32 s38, s30, 1
    s_lshl2_add_u32 s37, s38, s37
    s_add_u32 s37, s37, 1835008
    v_and_b32 v79, 7, v0
    v_lshl_add_u32 v79, v79, 8, s37
    s_lshl_b32 s37, s2, 8
    s_add_u32 s37, s37, 1835008
    s_add_u32 s54, s28, s37
    s_addc_u32 s55, s29, 0
    s_mov_b32 s56, s35
    s_mov_b32 s57, s35
L_w1:
    ds_read_b32 v7, v2 offset:0
    s_waitcnt lgkmcnt(0)
    v_cmp_le_u32 vcc, 40, v7
    s_cbranch_vccnz L_d2
    s_sleep 1
    s_cmp_eq_u32 s36, 0
    s_cbranch_scc1 L_d2
    s_sub_u32 s36, s36, 1
    s_branch L_w1
L_d2:
    global_load_dwordx4 v[80:83], v64, s[28:29] offset:0 sc1 nt
    global_load_dwordx4 v[84:87], v71, s[28:29] offset:1024 sc1 nt
L_w3:
    ds_read_b32 v7, v2 offset:0
    s_waitcnt lgkmcnt(0)
    v_cmp_le_u32 vcc, 52, v7
    s_cbranch_vccnz L_d4
    s_sleep 1
    s_cmp_eq_u32 s36, 0
    s_cbranch_scc1 L_d4
    s_sub_u32 s36, s36, 1
    s_branch L_w3
L_d4:
    global_load_dwordx4 v[56:59], v65, s[28:29] offset:0 sc1 nt
    global_load_dwordx4 v[60:63], v65, s[28:29] offset:1024 sc1 nt
    global_load_dwordx4 v[88:91], v64, s[28:29] offset:0 sc1 nt
    global_load_dwordx4 v[92:95], v71, s[28:29] offset:1024 sc1 nt
    s_waitcnt vmcnt(4)
    v_perm_b32 v12, v81, v80, s48
    v_perm_b32 v13, v83, v82, s49
    v_perm_b32 v14, v85, v84, s48
    v_perm_b32 v15, v87, v86, s49
    v_bitop3_b32 v12, v12, v13, s35 bitop3:0x56
    v_bitop3_b32 v14, v14, v15, s35 bitop3:0x56
    v_or_b32 v12, v12, v14
    v_cmp_ne_u32 vcc, 0, v12
    v_and_b32 v80, 0xffffff00, v80
    v_and_b32 v81, 0xffffff00, v81
    v_and_b32 v82, 0xffffff00, v82
    v_and_b32 v83, 0xffffff00, v83
    v_and_b32 v84, 0xffffff00, v84
    v_and_b32 v85, 0xffffff00, v85
    v_and_b32 v86, 0xffffff00, v86
    v_and_b32 v87, 0xffffff00, v87
    v_pk_add_f32 v[48:49], v[80:81], v[84:85]
    v_pk_add_f32 v[50:51], v[82:83], v[86:87]
    s_cbranch_vccz L_A_qok
    global_load_dwordx4 v[80:83], v64, s[28:29] offset:0 sc1 nt
    global_load_dwordx4 v[84:87], v71, s[28:29] offset:1024 sc1 nt
    s_branch L_A_qlast
L_A_qloop:
    s_waitcnt vmcnt(2)
    v_perm_b32 v12, v81, v80, s48
    v_perm_b32 v13, v83, v82, s49
    v_perm_b32 v14, v85, v84, s48
    v_perm_b32 v15, v87, v86, s49
    v_bitop3_b32 v12, v12, v13, s35 bitop3:0x56
    v_bitop3_b32 v14, v14, v15, s35 bitop3:0x56
    v_or_b32 v12, v12, v14
    v_cmp_ne_u32 vcc, 0, v12
    v_and_b32 v80, 0xffffff00, v80
    v_and_b32 v81, 0xffffff00, v81
    v_and_b32 v82, 0xffffff00, v82
    v_and_b32 v83, 0xffffff00, v83
    v_and_b32 v84, 0xffffff00, v84
    v_and_b32 v85, 0xffffff00, v85
    v_and_b32 v86, 0xffffff00, v86
    v_and_b32 v87, 0xffffff00, v87
    v_pk_add_f32 v[48:49], v[80:81], v[84:85]
    v_pk_add_f32 v[50:51], v[82:83], v[86:87]
    s_cbranch_vccz L_A_qok
    global_load_dwordx4 v[80:83], v64, s[28:29] offset:0 sc1 nt
    global_load_dwordx4 v[84:87], v71, s[28:29] offset:1024 sc1 nt
L_A_qlast:
    s_waitcnt vmcnt(2)
    v_perm_b32 v12, v89, v88, s48
    v_perm_b32 v13, v91, v90, s49
    v_perm_b32 v14, v93, v92, s48
    v_perm_b32 v15, v95, v94, s49
    v_bitop3_b32 v12, v12, v13, s35 bitop3:0x56
    v_bitop3_b32 v14, v14, v15, s35 bitop3:0x56
    v_or_b32 v12, v12, v14
    v_cmp_ne_u32 vcc, 0, v12
    v_and_b32 v88, 0xffffff00, v88
    v_and_b32 v89, 0xffffff00, v89
    v_and_b32 v90, 0xffffff00, v90
    v_and_b32 v91, 0xffffff00, v91
    v_and_b32 v92, 0xffffff00, v92
    v_and_b32 v93, 0xffffff00, v93
    v_and_b32 v94, 0xffffff00, v94
    v_and_b32 v95, 0xffffff00, v95
    v_pk_add_f32 v[48:49], v[88:89], v[92:93]
    v_pk_add_f32 v[50:51], v[90:91], v[94:95]
    s_cbranch_vccz L_A_qok
    global_load_dwordx4 v[88:91], v64, s[28:29] offset:0 sc1 nt
    global_load_dwordx4 v[92:95], v71, s[28:29] offset:1024 sc1 nt
    s_cmp_eq_u32 s36, 0
    s_cbranch_scc1 L_A_qok
    s_sub_u32 s36, s36, 1
    s_branch L_A_qloop
L_A_qok:
    s_nop 0
    v_permlane16_swap_b32 v48, v49
    v_permlane16_swap_b32 v50, v51
    v_add_f32 v48, v48, v49
    v_add_f32 v50, v50, v51
    v_cvt_pk_bf16_f32 v48, v48, v50
    ds_write_b16 v66, v48 offset:3200
    ds_write_b16_d16_hi v66, v48 offset:3264
    ds_add_u32 v134, v1 offset:768
    s_cmp_ge_u32 s33, 28
    s_cbranch_scc1 L_A_mlpdone
    s_waitcnt vmcnt(0)
L_c6:
    v_perm_b32 v12, v57, v56, s48
    v_perm_b32 v13, v59, v58, s49
    v_perm_b32 v14, v61, v60, s48
    v_perm_b32 v15, v63, v62, s49
    v_bitop3_b32 v12, v12, v13, s35 bitop3:0x56
    v_bitop3_b32 v14, v14, v15, s35 bitop3:0x56
    v_or_b32 v12, v12, v14
    v_cmp_ne_u32 vcc, 0, v12
    s_cbranch_vccz L_ok7
    s_mov_b64 exec, vcc
    s_cmp_eq_u32 s36, 0
    s_cbranch_scc1 L_ok7
    s_sub_u32 s36, s36, 1
    global_load_dwordx4 v[56:59], v65, s[28:29] offset:0 sc1 nt
    global_load_dwordx4 v[60:63], v65, s[28:29] offset:1024 sc1 nt
    s_waitcnt vmcnt(0)
    s_branch L_c6
L_ok7:
    s_mov_b64 exec, -1
    v_and_b32 v56, 0xffffff00, v56
    v_and_b32 v57, 0xffffff00, v57
    v_and_b32 v58, 0xffffff00, v58
    v_and_b32 v59, 0xffffff00, v59
    v_and_b32 v60, 0xffffff00, v60
    v_and_b32 v61, 0xffffff00, v61
    v_and_b32 v62, 0xffffff00, v62
    v_and_b32 v63, 0xffffff00, v63
    v_pk_add_f32 v[56:57], v[56:57], v[60:61]
    v_pk_add_f32 v[58:59], v[58:59], v[62:63]
    s_nop 0
    v_permlane32_swap_b32 v56, v57
    v_permlane32_swap_b32 v58, v59
    v_add_f32 v56, v56, v57
    v_add_f32 v58, v58, v59
    s_nop 1
    v_permlane16_swap_b32 v56, v58
    v_add_f32 v56, v56, v58
    v_cvt_pk_bf16_f32 v8, v56, v56
    v_lshlrev_b32 v8, 16, v8
    v_lshlrev_b32 v9, 16, v45
    v_add_f32 v8, v8, v9
    v_cvt_pk_bf16_f32 v8, v8, v8
    v_lshlrev_b32 v8, 16, v8
    v_mul_f32 v9, v8, v8
    v_mov_b32 v10, 0xc0135761
    v_fmac_f32 v10, 0xbdd2d3e8, v9
    v_mul_f32 v10, v10, v8
    v_exp_f32 v10, v10
    s_nop 0
    v_add_f32 v10, 1.0, v10
    v_rcp_f32 v10, v10
    s_nop 0
    v_mul_f32 v8, v8, v10
    v_cvt_pk_bf16_f32 v8, v8, v8
    ds_write_b16 v67, v8 offset:4288
    ds_add_u32 v134, v1 offset:1024
L_w8:
    ds_read_b32 v7, v2 offset:0
    s_waitcnt lgkmcnt(0)
    v_cmp_le_u32 vcc, 64, v7
    s_cbranch_vccnz L_d9
    s_sleep 1
    s_cmp_eq_u32 s36, 0
    s_cbranch_scc1 L_d9
    s_sub_u32 s36, s36, 1
    s_branch L_w8
L_d9:
    ds_read_b64_tr_b16 v[48:49], v68 offset:39424
    ds_read_b64_tr_b16 v[50:51], v68 offset:41472
    ds_read_b64_tr_b16 v[52:53], v68 offset:43520
    ds_read_b64_tr_b16 v[54:55], v68 offset:45568
L_w10:
    ds_read_b32 v7, v2 offset:1024
    ds_read2_b64 v[8:11], v69 offset0:0 offset1:4
    ds_read2_b64 v[12:15], v69 offset0:8 offset1:12
    s_waitcnt lgkmcnt(0)
    v_cmp_le_u32 vcc, 4, v7
    s_cbranch_vccnz L_d11
    s_cmp_eq_u32 s36, 0
    s_cbranch_scc1 L_d11
    s_sub_u32 s36, s36, 1
    s_branch L_w10
L_d11:
    v_mfma_f32_16x16x32_bf16 v[56:59], v[48:51], v[8:11], 0
    v_mfma_f32_16x16x32_bf16 v[56:59], v[52:55], v[12:15], v[56:59]
    s_nop 7
    v_perm_b32 v60, v56, v47, s44
    v_perm_b32 v61, v57, v47, s45
    v_perm_b32 v62, v58, v47, s46
    v_perm_b32 v63, v59, v47, s47
    s_mov_b64 exec, s[12:13]
    global_store_dwordx4 v70, v[60:63], s[28:29] sc1
    s_mov_b64 exec, -1
L_A_mlpdone:
    s_cmp_eq_u32 s34, 3
    s_cbranch_scc0 L_fin
    s_load_dwordx4 s[4:7], s[54:55], 0 glc
    s_load_dwordx4 s[8:11], s[54:55], 128 glc
L_w12:
    ds_read_b32 v7, v2 offset:0
    s_waitcnt lgkmcnt(0)
    v_cmp_le_u32 vcc, 96, v7
    s_cbranch_vccnz L_d13
    s_sleep 1
    s_cmp_eq_u32 s36, 0
    s_cbranch_scc1 L_d13
    s_sub_u32 s36, s36, 1
    s_branch L_w12
L_d13:
L_w14:
    ds_read_b32 v7, v2 offset:1536
    s_waitcnt lgkmcnt(0)
    v_cmp_le_u32 vcc, 4, v7
    s_cbranch_vccnz L_d15
    s_cmp_eq_u32 s36, 0
    s_cbranch_scc1 L_d15
    s_sub_u32 s36, s36, 1
    s_branch L_w14
L_d15:
    s_mov_b64 exec, 0xff
    global_store_dword v79, v47, s[28:29] sc1
    s_mov_b64 exec, -1
    global_load_dwordx4 v[32:35], v72, s[28:29] sc1
    s_not_b64 s[4:5], s[56:57]
    s_not_b64 s[6:7], s[56:57]
    s_not_b64 s[8:9], s[56:57]
    s_not_b64 s[10:11], s[56:57]
    s_load_dwordx4 s[4:7], s[54:55], 0 glc
    s_load_dwordx4 s[8:11], s[54:55], 128 glc
    s_sleep 2
    s_load_dwordx4 s[4:7], s[54:55], 0 glc
    s_load_dwordx4 s[8:11], s[54:55], 128 glc
    s_sleep 2
L_F_fl:
    s_load_dwordx4 s[4:7], s[54:55], 0 glc
    s_load_dwordx4 s[8:11], s[54:55], 128 glc
    s_waitcnt lgkmcnt(8)
    s_xor_b64 s[14:15], s[4:5], s[56:57]
    s_xor_b64 s[16:17], s[6:7], s[56:57]
    s_xor_b64 s[18:19], s[8:9], s[56:57]
    s_xor_b64 s[20:21], s[10:11], s[56:57]
    s_or_b64 s[14:15], s[14:15], s[16:17]
    s_or_b64 s[18:19], s[18:19], s[20:21]
    s_or_b64 s[14:15], s[14:15], s[18:19]
    s_cbranch_scc0 L_F_fld
    s_cmp_eq_u32 s36, 0
    s_cbranch_scc1 L_F_fld
    s_sub_u32 s36, s36, 1
    s_branch L_F_fl
L_F_fld:
    global_load_dwordx4 v[36:39], v73, s[28:29] sc1
    s_waitcnt vmcnt(1)
L_c17:
    v_perm_b32 v12, v33, v32, s48
    v_perm_b32 v13, v35, v34, s49
    v_or_b32 v12, v12, v13
    v_cmp_ne_u32 vcc, s35, v12
    s_cbranch_vccz L_ok18
    s_mov_b64 exec, vcc
    s_cmp_eq_u32 s36, 0
    s_cbranch_scc1 L_ok18
    s_sub_u32 s36, s36, 1
    global_load_dwordx4 v[32:35], v72, s[28:29] sc1
    s_waitcnt vmcnt(0)
    s_branch L_c17
L_ok18:
    s_mov_b64 exec, -1
    s_mov_b32 exec_lo, 0
    s_mov_b32 exec_hi, 0xff000000
    v_mov_b32 v32, 0
    v_mov_b32 v33, 0
    v_mov_b32 v34, 0
    v_mov_b32 v35, 0
    s_mov_b64 exec, -1
    v_and_b32 v32, 0xffffff00, v32
    v_and_b32 v33, 0xffffff00, v33
    v_and_b32 v34, 0xffffff00, v34
    v_and_b32 v35, 0xffffff00, v35
    v_permlane32_swap_b32 v32, v33
    s_nop 0
    v_permlane32_swap_b32 v34, v35
    v_add_f32 v32, v32, v33
    v_add_f32 v34, v34, v35
    s_nop 1
    v_permlane16_swap_b32 v32, v34
    v_add_f32 v32, v32, v34
    s_nop 1
    v_add_f32_dpp v32, v32, v32 row_ror:8 row_mask:0xf bank_mask:0xf
    s_nop 1
    v_add_f32_dpp v32, v32, v32 row_ror:4 row_mask:0xf bank_mask:0xf
    s_nop 1
    v_add_f32_dpp v32, v32, v32 quad_perm:[2,3,0,1] row_mask:0xf bank_mask:0xf
    v_cvt_pk_bf16_f32 v8, v32, v32
    v_lshlrev_b32 v8, 16, v8
    v_lshlrev_b32 v9, 16, v76
    v_add_f32 v8, v8, v9
    v_cvt_pk_bf16_f32 v8, v8, v8
    v_lshlrev_b32 v8, 16, v8
    v_mul_f32 v10, 0xbfb8aa3b, v8
    v_exp_f32 v10, v10
    s_nop 0
    v_add_f32 v10, 1.0, v10
    v_rcp_f32 v10, v10
    s_nop 0
    v_mul_f32 v8, v8, v10
    v_cvt_pk_bf16_f32 v16, v8, v8
    v_lshlrev_b32 v16, 16, v16
    v_lshlrev_b32 v17, 16, v77
    s_mov_b32 s58, 0x00030003
    s_mov_b32 s59, s58
    s_waitcnt vmcnt(0)
L_c20:
    v_perm_b32 v12, v37, v36, s48
    v_perm_b32 v13, v39, v38, s49
    v_or_b32 v12, v12, v13
    v_cmp_ne_u32 vcc, s35, v12
    s_cbranch_vccz L_ok21
    s_mov_b64 exec, vcc
    s_cmp_eq_u32 s36, 0
    s_cbranch_scc1 L_ok21
    s_sub_u32 s36, s36, 1
    global_load_dwordx4 v[36:39], v73, s[28:29] sc1
    s_waitcnt vmcnt(0)
    s_branch L_c20
L_ok21:
    s_mov_b64 exec, -1
    v_and_b32 v36, 0xffffff00, v36
    v_and_b32 v37, 0xffffff00, v37
    v_and_b32 v38, 0xffffff00, v38
    v_and_b32 v39, 0xffffff00, v39
    v_permlane32_swap_b32 v36, v37
    s_nop 0
    v_permlane32_swap_b32 v38, v39
    v_add_f32 v36, v36, v37
    v_add_f32 v38, v38, v39
    s_nop 1
    v_permlane16_swap_b32 v36, v38
    v_add_f32 v36, v36, v38
    s_nop 1
    v_add_f32_dpp v36, v36, v36 row_ror:8 row_mask:0xf bank_mask:0xf
    s_nop 1
    v_add_f32_dpp v36, v36, v36 row_ror:4 row_mask:0xf bank_mask:0xf
    s_nop 1
    v_add_f32_dpp v36, v36, v36 quad_perm:[2,3,0,1] row_mask:0xf bank_mask:0xf
    v_cvt_pk_bf16_f32 v8, v36, v36
    v_lshlrev_b32 v8, 16, v8
    v_mul_f32 v8, v8, v16
    v_cvt_pk_bf16_f32 v8, v8, v8
    v_lshlrev_b32 v8, 16, v8
    v_add_f32 v8, v8, v17
    v_cvt_pk_bf16_f32 v8, v8, v8
    s_mov_b64 exec, s[58:59]
    global_store_short v75, v8, s[24:25]
    s_cmp_eq_u32 s2, 0
    s_cbranch_scc0 L_F_done
    s_mov_b64 exec, 1
    v_mov_b32 v9, s62
    global_store_dword v2, v9, s[28:29]
L_F_done:
    s_endpgm
L_B:
    s_barrier
    v_lshrrev_b32 v5, 2, v0
    v_bfe_u32 v6, v0, 3, 2
    v_xor_b32 v6, s34, v6
    v_lshlrev_b32 v6, 5, v6
    v_lshl_add_u32 v5, v5, 7, v6
    v_and_b32 v6, 3, v0
    v_lshl_add_u32 v53, v6, 3, v5
    v_lshrrev_b32 v4, 4, v0
    v_bfe_u32 v5, v0, 2, 2
    s_waitcnt lgkmcnt(0)
    s_mov_b32 s44, 0x07060500
    s_mov_b32 s45, 0x07060501
    s_mov_b32 s46, 0x07060502
    s_mov_b32 s47, 0x07060503
    s_mov_b32 s48, 0x0c0c0400
    s_mov_b32 s49, 0x04000c0c
    s_mov_b32 s12, 0x000f000f
    s_mov_b32 s13, s12
    s_mov_b32 s36, 0x200000
    s_mov_b64 s[6:7], 0
    v_mov_b32 v132, 0
    s_cmp_ge_u32 s34, 2
    s_cbranch_scc1 L_B_att
    v_mul_u32_u24 v44, 1088, v5
    v_lshl_add_u32 v44, v4, 3, v44
    s_lshl_b32 s37, s34, 5
    v_xor_b32 v40, s37, v53
    v_xor_b32 v41, 32, v40
    v_xor_b32 v42, 64, v40
    v_xor_b32 v43, 32, v42
    s_cmp_eq_u32 s34, 0
    s_cbranch_scc0 L_B_h
    s_lshl_b32 s37, s31, 8
    s_add_u32 s37, s37, 5952
    v_add_u32 v44, s37, v44
    s_lshl3_add_u32 s37, s30, s32
    s_lshl2_add_u32 s37, s37, s31
    s_lshl_b32 s37, s37, 10
    s_add_u32 s37, s37, 262144
    v_add_u32 v132, s37, v3
    s_lshl_b32 s37, s31, 8
    v_xor_b32 v132, s37, v132
L_w22:
    ds_read_b32 v7, v2 offset:256
    ds_read2_b64 v[8:11], v44 offset0:0 offset1:4
    ds_read2_b64 v[12:15], v44 offset0:8 offset1:12
    ds_read2_b64 v[16:19], v44 offset0:16 offset1:20
    ds_read2_b64 v[20:23], v44 offset0:24 offset1:28
    ds_read_b32 v46, v2 offset:2560
    s_waitcnt lgkmcnt(0)
    v_cmp_le_u32 vcc, 4, v7
    s_cbranch_vccnz L_d23
    s_sleep 1
    s_cmp_eq_u32 s36, 0
    s_cbranch_scc1 L_d23
    s_sub_u32 s36, s36, 1
    s_branch L_w22
L_d23:
L_w24:
    ds_read_b32 v7, v2 offset:0
    s_waitcnt lgkmcnt(0)
    v_cmp_le_u32 vcc, 8, v7
    s_cbranch_vccnz L_d25
    s_cmp_eq_u32 s36, 0
    s_cbranch_scc1 L_d25
    s_sub_u32 s36, s36, 1
    s_branch L_w24
L_d25:
    ds_read_b64_tr_b16 v[64:65], v40 offset:14848
    ds_read_b64_tr_b16 v[66:67], v40 offset:16896
    ds_read_b64_tr_b16 v[68:69], v40 offset:18944
    ds_read_b64_tr_b16 v[70:71], v40 offset:20992
    ds_read_b64_tr_b16 v[80:81], v41 offset:14848
    ds_read_b64_tr_b16 v[82:83], v41 offset:16896
    ds_read_b64_tr_b16 v[84:85], v41 offset:18944
    ds_read_b64_tr_b16 v[86:87], v41 offset:20992
    ds_read_b64_tr_b16 v[96:97], v42 offset:14848
    ds_read_b64_tr_b16 v[98:99], v42 offset:16896
    ds_read_b64_tr_b16 v[100:101], v42 offset:18944
    ds_read_b64_tr_b16 v[102:103], v42 offset:20992
    ds_read_b64_tr_b16 v[112:113], v43 offset:14848
    ds_read_b64_tr_b16 v[114:115], v43 offset:16896
    ds_read_b64_tr_b16 v[116:117], v43 offset:18944
    ds_read_b64_tr_b16 v[118:119], v43 offset:20992
    s_waitcnt lgkmcnt(12)
    v_mfma_f32_16x16x32_bf16 v[24:27], v[8:11], v[64:67], 0
    v_mfma_f32_16x16x32_bf16 v[24:27], v[12:15], v[68:71], v[24:27]
    s_waitcnt lgkmcnt(8)
    v_mfma_f32_16x16x32_bf16 v[28:31], v[8:11], v[80:83], 0
    v_mfma_f32_16x16x32_bf16 v[28:31], v[12:15], v[84:87], v[28:31]
    s_waitcnt lgkmcnt(4)
    v_mfma_f32_16x16x32_bf16 v[32:35], v[8:11], v[96:99], 0
    v_mfma_f32_16x16x32_bf16 v[32:35], v[12:15], v[100:103], v[32:35]
    s_waitcnt lgkmcnt(0)
    v_mfma_f32_16x16x32_bf16 v[36:39], v[8:11], v[112:115], 0
    v_mfma_f32_16x16x32_bf16 v[36:39], v[12:15], v[116:119], v[36:39]
L_w26:
    ds_read_b32 v7, v2 offset:0
    s_waitcnt lgkmcnt(0)
    v_cmp_le_u32 vcc, 16, v7
    s_cbranch_vccnz L_d27
    s_cmp_eq_u32 s36, 0
    s_cbranch_scc1 L_d27
    s_sub_u32 s36, s36, 1
    s_branch L_w26
L_d27:
    ds_read_b64_tr_b16 v[72:73], v40 offset:23040
    ds_read_b64_tr_b16 v[74:75], v40 offset:25088
    ds_read_b64_tr_b16 v[76:77], v40 offset:27136
    ds_read_b64_tr_b16 v[78:79], v40 offset:29184
    ds_read_b64_tr_b16 v[88:89], v41 offset:23040
    ds_read_b64_tr_b16 v[90:91], v41 offset:25088
    ds_read_b64_tr_b16 v[92:93], v41 offset:27136
    ds_read_b64_tr_b16 v[94:95], v41 offset:29184
    ds_read_b64_tr_b16 v[104:105], v42 offset:23040
    ds_read_b64_tr_b16 v[106:107], v42 offset:25088
    ds_read_b64_tr_b16 v[108:109], v42 offset:27136
    ds_read_b64_tr_b16 v[110:111], v42 offset:29184
    ds_read_b64_tr_b16 v[120:121], v43 offset:23040
    ds_read_b64_tr_b16 v[122:123], v43 offset:25088
    ds_read_b64_tr_b16 v[124:125], v43 offset:27136
    ds_read_b64_tr_b16 v[126:127], v43 offset:29184
    s_waitcnt lgkmcnt(12)
    v_mfma_f32_16x16x32_bf16 v[24:27], v[16:19], v[72:75], v[24:27]
    v_mfma_f32_16x16x32_bf16 v[24:27], v[20:23], v[76:79], v[24:27]
    s_waitcnt lgkmcnt(8)
    v_mfma_f32_16x16x32_bf16 v[28:31], v[16:19], v[88:91], v[28:31]
    v_mfma_f32_16x16x32_bf16 v[28:31], v[20:23], v[92:95], v[28:31]
    s_waitcnt lgkmcnt(4)
    v_mfma_f32_16x16x32_bf16 v[32:35], v[16:19], v[104:107], v[32:35]
    v_mfma_f32_16x16x32_bf16 v[32:35], v[20:23], v[108:111], v[32:35]
    s_waitcnt lgkmcnt(0)
    v_mfma_f32_16x16x32_bf16 v[36:39], v[16:19], v[120:123], v[36:39]
    v_mfma_f32_16x16x32_bf16 v[36:39], v[20:23], v[124:127], v[36:39]
    s_branch L_B_pub
L_B_h:
    s_cmp_ge_u32 s33, 28
    s_cbranch_scc1 L_B_att
    s_lshl_b32 s37, s32, 7
    s_add_u32 s37, s37, 10304
    v_add_u32 v44, s37, v44
    s_lshl3_add_u32 s37, s33, s32
    s_lshl_b32 s37, s37, 10
    s_add_u32 s37, s37, 524288
    v_add_u32 v132, s37, v3
L_w28:
    ds_read_b32 v7, v2 offset:512
    ds_read2_b64 v[8:11], v44 offset0:0 offset1:4
    ds_read2_b64 v[12:15], v44 offset0:8 offset1:12
    ds_read_b32 v46, v2 offset:2560
    s_waitcnt lgkmcnt(0)
    v_cmp_le_u32 vcc, 4, v7
    s_cbranch_vccnz L_d29
    s_sleep 1
    s_cmp_eq_u32 s36, 0
    s_cbranch_scc1 L_d29
    s_sub_u32 s36, s36, 1
    s_branch L_w28
L_d29:
L_w30:
    ds_read_b32 v7, v2 offset:0
    s_waitcnt lgkmcnt(0)
    v_cmp_le_u32 vcc, 24, v7
    s_cbranch_vccnz L_d31
    s_sleep 1
    s_cmp_eq_u32 s36, 0
    s_cbranch_scc1 L_d31
    s_sub_u32 s36, s36, 1
    s_branch L_w30
L_d31:
    ds_read_b64_tr_b16 v[64:65], v40 offset:31232
    ds_read_b64_tr_b16 v[66:67], v40 offset:33280
    ds_read_b64_tr_b16 v[68:69], v40 offset:35328
    ds_read_b64_tr_b16 v[70:71], v40 offset:37376
    ds_read_b64_tr_b16 v[80:81], v41 offset:31232
    ds_read_b64_tr_b16 v[82:83], v41 offset:33280
    ds_read_b64_tr_b16 v[84:85], v41 offset:35328
    ds_read_b64_tr_b16 v[86:87], v41 offset:37376
    ds_read_b64_tr_b16 v[96:97], v42 offset:31232
    ds_read_b64_tr_b16 v[98:99], v42 offset:33280
    ds_read_b64_tr_b16 v[100:101], v42 offset:35328
    ds_read_b64_tr_b16 v[102:103], v42 offset:37376
    ds_read_b64_tr_b16 v[112:113], v43 offset:31232
    ds_read_b64_tr_b16 v[114:115], v43 offset:33280
    ds_read_b64_tr_b16 v[116:117], v43 offset:35328
    ds_read_b64_tr_b16 v[118:119], v43 offset:37376
    s_waitcnt lgkmcnt(0)
    v_mfma_f32_16x16x32_bf16 v[24:27], v[8:11], v[64:67], 0
    v_mfma_f32_16x16x32_bf16 v[24:27], v[12:15], v[68:71], v[24:27]
    v_mfma_f32_16x16x32_bf16 v[28:31], v[8:11], v[80:83], 0
    v_mfma_f32_16x16x32_bf16 v[28:31], v[12:15], v[84:87], v[28:31]
    v_mfma_f32_16x16x32_bf16 v[32:35], v[8:11], v[96:99], 0
    v_mfma_f32_16x16x32_bf16 v[32:35], v[12:15], v[100:103], v[32:35]
    v_mfma_f32_16x16x32_bf16 v[36:39], v[8:11], v[112:115], 0
    v_mfma_f32_16x16x32_bf16 v[36:39], v[12:15], v[116:119], v[36:39]
L_B_pub:
    s_nop 4
    v_perm_b32 v128, v24, v46, s44
    v_perm_b32 v129, v28, v46, s45
    v_perm_b32 v130, v32, v46, s46
    v_perm_b32 v131, v36, v46, s47
    global_store_dwordx4 v132, v[128:131], s[28:29]
    s_mov_b64 s[6:7], -1
L_B_att:
    v_mul_u32_u24 v8, 1040, v5
    v_lshl_add_u32 v8, v6, 8, v8
    v_lshl_add_u32 v8, v4, 4, v8
    s_mul_i32 s37, s34, 8320
    s_add_u32 s37, s37, 68096
    v_add_u32 v8, s37, v8
    v_xor_b32 v7, 0, v6
    v_lshl_add_u32 v40, v7, 6, v8
    v_xor_b32 v7, 1, v6
    v_lshl_add_u32 v41, v7, 6, v8
    v_xor_b32 v7, 2, v6
    v_lshl_add_u32 v42, v7, 6, v8
    v_xor_b32 v7, 3, v6
    v_lshl_add_u32 v43, v7, 6, v8
    v_mul_u32_u24 v44, 272, v5
    v_lshl_add_u32 v44, v4, 4, v44
    v_mul_u32_u24 v7, 1152, v4
    v_lshl_add_u32 v7, v5, 8, v7
    v_lshl_add_u32 v7, v6, 3, v7
    v_add_u32 v7, 101376, v7
    s_lshl_b32 s37, s34, 1
    v_xor_b32 v8, s37, v5
    v_lshl_add_u32 v45, v8, 5, v7
    v_xor_b32 v8, 1, v8
    v_lshl_add_u32 v46, v8, 5, v7
    v_lshlrev_b32 v48, 5, v4
    s_lshl_b32 s37, s34, 3
    v_add_u32 v47, s37, v48
    v_add_u32 v61, 64000, v3
    s_lshl_b32 s37, s34, 10
    v_add_u32 v49, s37, v61
    s_lshl_b32 s37, s30, 7
    s_lshr_b32 s38, s2, 3
    s_add_u32 s37, s37, s38
    s_lshl_b32 s37, s37, 9
    s_lshl_b32 s38, s34, 7
    s_add_u32 s37, s37, s38
    s_add_u32 s37, s37, 786432
    v_and_b32 v7, 7, v0
    v_lshlrev_b32 v8, 4, v7
    v_lshl_add_u32 v8, v4, 14, v8
    v_add_u32 v50, s37, v8
    s_lshl2_add_u32 s39, s30, s31
    s_lshl_b32 s37, s39, 14
    s_lshl_b32 s38, s34, 12
    s_add_u32 s37, s37, s38
    s_add_u32 s37, s37, 786432
    v_lshl_add_u32 v7, v4, 3, v7
    v_lshl_add_u32 v51, v7, 4, s37
    v_bfe_u32 v8, v0, 3, 1
    v_lshl_add_u32 v51, v8, 11, v51
    s_mul_i32 s37, s34, 272
    v_lshlrev_b32 v8, 1, v6
    v_and_or_b32 v8, v7, 24, v8
    v_bfe_u32 v7, v7, 2, 1
    v_or_b32 v7, v7, v8
    v_lshl_add_u32 v52, v7, 3, s37
    v_mul_u32_u24 v54, 272, v6
    v_lshl_add_u32 v54, v4, 4, v54
    v_lshlrev_b32 v55, 4, v6
    v_lshl_add_u32 v55, v4, 6, v55
    s_xor_b32 s38, s32, 5
    s_lshl_b32 s38, s38, 5
    s_add_u32 s37, s39, s38
    s_lshl2_add_u32 s37, s37, s34
    s_lshl_b32 s37, s37, 8
    s_add_u32 s37, s37, 1572864
    v_add_u32 v55, s37, v55
    v_mov_b32 v28, 0x3f803f80
    v_mov_b32 v29, v28
    v_mov_b32 v30, v28
    v_mov_b32 v31, v28
    s_mov_b32 s10, 0x00ff00ff
    s_mov_b32 s11, s10
    s_mov_b32 s14, 0x00100001
    s_mov_b32 s15, 0x10000100
    s_mov_b32 s42, 0x3e0293ee
    s_lshl3_add_u32 s43, s34, 32
L_w32:
    ds_read_b32 v7, v2 offset:0
    s_waitcnt lgkmcnt(0)
    v_cmp_le_u32 vcc, s43, v7
    s_cbranch_vccnz L_d33
    s_sleep 2
    s_cmp_eq_u32 s36, 0
    s_cbranch_scc1 L_d33
    s_sub_u32 s36, s36, 1
    s_branch L_w32
L_d33:
    ds_read_b128 v[64:67], v40 offset:0
    ds_read_b128 v[68:71], v41 offset:0
    ds_read_b128 v[72:75], v42 offset:0
    ds_read_b128 v[76:79], v43 offset:0
    ds_read_b128 v[80:83], v40 offset:4160
    ds_read_b128 v[84:87], v41 offset:4160
    ds_read_b128 v[88:91], v42 offset:4160
    ds_read_b128 v[92:95], v43 offset:4160
    s_mov_b32 s51, 64
L_w34:
    ds_read_b32 v7, v2 offset:768
    ds_read_b128 v[96:99], v44 offset:3200
    ds_read_b128 v[100:103], v44 offset:3264
    ds_read_b128 v[104:107], v44 offset:3328
    ds_read_b128 v[108:111], v44 offset:3392
    s_waitcnt lgkmcnt(0)
    v_cmp_le_u32 vcc, 4, v7
    s_cbranch_vccnz L_d35
    s_cmp_eq_u32 s36, 0
    s_cbranch_scc1 L_d35
    s_sub_u32 s36, s36, 1
    s_sub_u32 s51, s51, 1
    s_cbranch_scc1 L_r36
    s_branch L_w34
L_d35:
    v_mfma_f32_16x16x32_bf16 v[16:19], v[64:67], v[96:99], 0
    v_mfma_f32_16x16x32_bf16 v[20:23], v[80:83], v[96:99], 0
    v_mfma_f32_16x16x32_bf16 v[16:19], v[68:71], v[100:103], v[16:19]
    v_mfma_f32_16x16x32_bf16 v[20:23], v[84:87], v[100:103], v[20:23]
    v_mfma_f32_16x16x32_bf16 v[16:19], v[72:75], v[104:107], v[16:19]
    v_mfma_f32_16x16x32_bf16 v[20:23], v[88:91], v[104:107], v[20:23]
    v_mfma_f32_16x16x32_bf16 v[16:19], v[76:79], v[108:111], v[16:19]
    v_mfma_f32_16x16x32_bf16 v[20:23], v[92:95], v[108:111], v[20:23]
    ds_read_b32 v59, v2 offset:2560
    s_nop 5
    v_max3_f32 v24, v16, v17, v18
    v_max3_f32 v25, v19, v20, v21
    v_max3_f32 v24, v24, v22, v23
    v_max_f32 v24, v24, v25
    v_mov_b32 v25, v24
    s_nop 1
    v_permlane16_swap_b32 v24, v25
    v_max_f32 v24, v24, v25
    v_mov_b32 v25, v24
    s_nop 1
    v_permlane32_swap_b32 v24, v25
    v_max_f32 v24, v24, v25
    v_mul_f32 v24, s42, v24
    v_pk_fma_f32 v[16:17], v[16:17], s[42:43], v[24:25] op_sel_hi:[1,0,0] neg_lo:[0,0,1] neg_hi:[0,0,1]
    v_pk_fma_f32 v[18:19], v[18:19], s[42:43], v[24:25] op_sel_hi:[1,0,0] neg_lo:[0,0,1] neg_hi:[0,0,1]
    v_pk_fma_f32 v[20:21], v[20:21], s[42:43], v[24:25] op_sel_hi:[1,0,0] neg_lo:[0,0,1] neg_hi:[0,0,1]
    v_pk_fma_f32 v[22:23], v[22:23], s[42:43], v[24:25] op_sel_hi:[1,0,0] neg_lo:[0,0,1] neg_hi:[0,0,1]
    v_exp_f32 v16, v16
    v_exp_f32 v17, v17
    v_exp_f32 v18, v18
    v_exp_f32 v19, v19
    v_exp_f32 v20, v20
    v_exp_f32 v21, v21
    v_exp_f32 v22, v22
    v_exp_f32 v23, v23
    v_cvt_pk_bf16_f32 v8, v16, v17
    v_cvt_pk_bf16_f32 v9, v18, v19
    v_cvt_pk_bf16_f32 v10, v20, v21
    v_cvt_pk_bf16_f32 v11, v22, v23
    s_nop 1
    v_mfma_f32_16x16x32_bf16 v[12:15], v[8:11], v[28:31], 0
    ds_write_b128 v49, v[8:11]
    s_nop 6
    v_mov_b32 v25, v12
    s_mov_b64 exec, s[14:15]
    ds_write_b64 v47, v[24:25] offset:3072
    s_mov_b64 exec, -1
    ds_add_u32 v134, v1 offset:1280
    ds_read_b32 v60, v2 offset:0
    ds_read_b64_tr_b16 v[80:81], v45 offset:0
    ds_read_b64_tr_b16 v[82:83], v45 offset:4608
    ds_read_b64_tr_b16 v[84:85], v46 offset:0
    ds_read_b64_tr_b16 v[86:87], v46 offset:4608
    ds_read_b64_tr_b16 v[88:89], v45 offset:9216
    ds_read_b64_tr_b16 v[90:91], v45 offset:13824
    ds_read_b64_tr_b16 v[92:93], v46 offset:9216
    ds_read_b64_tr_b16 v[94:95], v46 offset:13824
    ds_read_b64_tr_b16 v[96:97], v45 offset:18432
    ds_read_b64_tr_b16 v[98:99], v45 offset:23040
    ds_read_b64_tr_b16 v[100:101], v46 offset:18432
    ds_read_b64_tr_b16 v[102:103], v46 offset:23040
    ds_read_b64_tr_b16 v[104:105], v45 offset:27648
    ds_read_b64_tr_b16 v[106:107], v45 offset:32256
    ds_read_b64_tr_b16 v[108:109], v46 offset:27648
    ds_read_b64_tr_b16 v[110:111], v46 offset:32256
L_w37:
    ds_read_b32 v7, v2 offset:1280
    ds_read_b128 v[8:11], v48 offset:3072
    ds_read_b128 v[12:15], v48 offset:3088
    ds_read_b128 v[64:67], v61 offset:0
    ds_read_b128 v[68:71], v61 offset:1024
    ds_read_b128 v[72:75], v61 offset:2048
    ds_read_b128 v[76:79], v61 offset:3072
    s_waitcnt lgkmcnt(0)
    v_cmp_le_u32 vcc, 4, v7
    s_cbranch_vccnz L_d38
    s_cmp_eq_u32 s36, 0
    s_cbranch_scc1 L_d38
    s_sub_u32 s36, s36, 1
    s_branch L_w37
L_d38:
    v_mfma_f32_16x16x32_bf16 v[112:115], v[64:67], v[80:83], 0
    v_mfma_f32_16x16x32_bf16 v[116:119], v[64:67], v[84:87], 0
    v_mfma_f32_16x16x32_bf16 v[120:123], v[68:71], v[88:91], 0
    v_mfma_f32_16x16x32_bf16 v[124:127], v[68:71], v[92:95], 0
    v_mfma_f32_16x16x32_bf16 v[32:35], v[72:75], v[96:99], 0
    v_mfma_f32_16x16x32_bf16 v[36:39], v[72:75], v[100:103], 0
    v_mfma_f32_16x16x32_bf16 v[136:139], v[76:79], v[104:107], 0
    v_mfma_f32_16x16x32_bf16 v[140:143], v[76:79], v[108:111], 0
    v_readfirstlane_b32 s35, v59
    v_max3_f32 v16, v8, v10, v12
    v_max_f32 v16, v16, v14
    v_sub_f32 v8, v8, v16
    v_sub_f32 v10, v10, v16
    v_sub_f32 v12, v12, v16
    v_sub_f32 v14, v14, v16
    v_exp_f32 v8, v8
    v_exp_f32 v10, v10
    v_exp_f32 v12, v12
    v_exp_f32 v14, v14
    v_mul_f32 v17, v8, v9
    v_fmac_f32 v17, v10, v11
    v_fmac_f32 v17, v12, v13
    v_fmac_f32 v17, v14, v15
    v_rcp_f32 v18, v17
    v_log_f32 v58, v17
    v_mul_f32 v8, v8, v18
    v_mul_f32 v10, v10, v18
    v_mul_f32 v12, v12, v18
    v_mul_f32 v14, v14, v18
    v_add_f32 v58, v58, v16
    v_mul_f32 v20, v8, v112
    v_mul_f32 v21, v8, v116
    v_fmac_f32 v20, v10, v120
    v_fmac_f32 v21, v10, v124
    v_cmp_le_u32 vcc, 96, v60
    s_cbranch_vccnz L_B_pvlast
    v_cmp_le_u32 vcc, 88, v60
    s_cbranch_vccnz L_B_pv3
    v_cmp_le_u32 vcc, 80, v60
    s_cbranch_vccnz L_B_pv2
L_w39:
    ds_read_b32 v7, v2 offset:0
    s_waitcnt lgkmcnt(0)
    v_cmp_le_u32 vcc, 80, v7
    s_cbranch_vccnz L_d40
    s_cmp_eq_u32 s36, 0
    s_cbranch_scc1 L_d40
    s_sub_u32 s36, s36, 1
    s_branch L_w39
L_d40:
    ds_read_b64_tr_b16 v[80:81], v45 offset:0
    ds_read_b64_tr_b16 v[82:83], v45 offset:4608
    ds_read_b64_tr_b16 v[84:85], v46 offset:0
    ds_read_b64_tr_b16 v[86:87], v46 offset:4608
    ds_read_b64_tr_b16 v[88:89], v45 offset:9216
    ds_read_b64_tr_b16 v[90:91], v45 offset:13824
    ds_read_b64_tr_b16 v[92:93], v46 offset:9216
    ds_read_b64_tr_b16 v[94:95], v46 offset:13824
    s_waitcnt lgkmcnt(0)
    v_mfma_f32_16x16x32_bf16 v[112:115], v[64:67], v[80:83], 0
    v_mfma_f32_16x16x32_bf16 v[116:119], v[64:67], v[84:87], 0
    v_mfma_f32_16x16x32_bf16 v[120:123], v[68:71], v[88:91], 0
    v_mfma_f32_16x16x32_bf16 v[124:127], v[68:71], v[92:95], 0
    s_nop 4
    v_mul_f32 v20, v8, v112
    v_mul_f32 v21, v8, v116
    v_fmac_f32 v20, v10, v120
    v_fmac_f32 v21, v10, v124
L_B_pv2:
L_w41:
    ds_read_b32 v7, v2 offset:0
    s_waitcnt lgkmcnt(0)
    v_cmp_le_u32 vcc, 88, v7
    s_cbranch_vccnz L_d42
    s_cmp_eq_u32 s36, 0
    s_cbranch_scc1 L_d42
    s_sub_u32 s36, s36, 1
    s_branch L_w41
L_d42:
    ds_read_b64_tr_b16 v[96:97], v45 offset:18432
    ds_read_b64_tr_b16 v[98:99], v45 offset:23040
    ds_read_b64_tr_b16 v[100:101], v46 offset:18432
    ds_read_b64_tr_b16 v[102:103], v46 offset:23040
    ds_read_b32 v7, v2 offset:0
    ds_read_b64_tr_b16 v[104:105], v45 offset:27648
    ds_read_b64_tr_b16 v[106:107], v45 offset:32256
    ds_read_b64_tr_b16 v[108:109], v46 offset:27648
    ds_read_b64_tr_b16 v[110:111], v46 offset:32256
    s_waitcnt lgkmcnt(0)
    v_mfma_f32_16x16x32_bf16 v[32:35], v[72:75], v[96:99], 0
    v_mfma_f32_16x16x32_bf16 v[36:39], v[72:75], v[100:103], 0
    v_cmp_le_u32 vcc, 96, v7
    s_cbranch_vccnz L_B_pv3d
L_B_pv3:
L_w43:
    ds_read_b32 v7, v2 offset:0
    ds_read_b64_tr_b16 v[104:105], v45 offset:27648
    ds_read_b64_tr_b16 v[106:107], v45 offset:32256
    ds_read_b64_tr_b16 v[108:109], v46 offset:27648
    ds_read_b64_tr_b16 v[110:111], v46 offset:32256
    s_waitcnt lgkmcnt(0)
    v_cmp_le_u32 vcc, 96, v7
    s_cbranch_vccnz L_d44
    s_cmp_eq_u32 s36, 0
    s_cbranch_scc1 L_d44
    s_sub_u32 s36, s36, 1
    s_branch L_w43
L_d44:
L_B_pv3d:
    v_mfma_f32_16x16x32_bf16 v[136:139], v[76:79], v[104:107], 0
    v_mfma_f32_16x16x32_bf16 v[140:143], v[76:79], v[108:111], 0
    s_nop 4
L_B_pvlast:
    v_fmac_f32 v20, v12, v32
    v_fmac_f32 v21, v12, v36
    v_fmac_f32 v20, v14, v136
    v_fmac_f32 v21, v14, v140
    v_cvt_pk_bf16_f32 v56, v20, v21
    s_mov_b32 s51, 32
    s_nop 0
    v_mov_b32_dpp v57, v56 row_ror:8 row_mask:0xf bank_mask:0xf
    s_mov_b64 exec, s[10:11]
    global_store_dwordx4 v50, v[56:59], s[28:29]
    s_mov_b64 exec, -1
    ds_add_u32 v134, v1 offset:1792
L_w45:
    ds_read_b32 v7, v2 offset:1792
    s_waitcnt lgkmcnt(0)
    v_cmp_le_u32 vcc, 4, v7
    s_cbranch_vccnz L_d46
    s_cmp_eq_u32 s36, 0
    s_cbranch_scc1 L_d46
    s_sub_u32 s36, s36, 1
    s_branch L_w45
L_d46:
    global_load_dwordx4 v[64:67], v51, s[28:29] offset:0 sc1 nt
    global_load_dwordx4 v[68:71], v51, s[28:29] offset:512 sc1 nt
    global_load_dwordx4 v[72:75], v51, s[28:29] offset:1024 sc1 nt
    global_load_dwordx4 v[76:79], v51, s[28:29] offset:1536 sc1 nt
L_B_og:
    s_waitcnt vmcnt(0)
    v_cmp_ne_u32 s[52:53], s35, v67
    v_cmp_ne_u32 s[54:55], s35, v71
    v_cmp_ne_u32 s[56:57], s35, v75
    v_cmp_ne_u32 s[58:59], s35, v79
    s_or_b64 s[60:61], s[52:53], s[54:55]
    s_or_b64 s[62:63], s[56:57], s[58:59]
    s_or_b64 s[60:61], s[60:61], s[62:63]
    s_cbranch_scc0 L_B_ogd
    s_mov_b64 exec, s[52:53]
    global_load_dwordx4 v[64:67], v51, s[28:29] offset:0 sc1 nt
    s_mov_b64 exec, s[54:55]
    global_load_dwordx4 v[68:71], v51, s[28:29] offset:512 sc1 nt
    s_mov_b64 exec, s[56:57]
    global_load_dwordx4 v[72:75], v51, s[28:29] offset:1024 sc1 nt
    s_mov_b64 exec, s[58:59]
    global_load_dwordx4 v[76:79], v51, s[28:29] offset:1536 sc1 nt
    s_mov_b64 exec, -1
    s_cmp_eq_u32 s36, 0
    s_cbranch_scc1 L_B_ogw
    s_sub_u32 s36, s36, 1
    s_sub_u32 s51, s51, 1
    s_cbranch_scc1 L_r47
    s_branch L_B_og
L_B_ogw:
    s_waitcnt vmcnt(0)
L_B_ogd:
    v_max3_f32 v16, v66, v70, v74
    v_max_f32 v16, v16, v78
    v_lshlrev_b32 v80, 16, v64
    v_and_b32 v81, 0xffff0000, v64
    v_lshlrev_b32 v84, 16, v68
    v_and_b32 v85, 0xffff0000, v68
    v_max_f32_dpp v16, v16, v16 row_ror:8 row_mask:0xf bank_mask:0xf
    v_sub_f32 v8, v66, v16
    v_sub_f32 v9, v70, v16
    v_sub_f32 v10, v74, v16
    v_sub_f32 v11, v78, v16
    v_exp_f32 v8, v8
    v_exp_f32 v9, v9
    v_exp_f32 v10, v10
    v_exp_f32 v11, v11
    v_lshlrev_b32 v88, 16, v72
    v_and_b32 v89, 0xffff0000, v72
    v_lshlrev_b32 v92, 16, v76
    v_and_b32 v93, 0xffff0000, v76
    ds_read_b32 v63, v2 offset:0
    ds_read_b64_tr_b16 v[96:97], v53 offset:47616
    ds_read_b64_tr_b16 v[98:99], v53 offset:49664
    ds_read_b64_tr_b16 v[100:101], v53 offset:51712
    ds_read_b64_tr_b16 v[102:103], v53 offset:53760
    ds_read_b64_tr_b16 v[104:105], v53 offset:55808
    ds_read_b64_tr_b16 v[106:107], v53 offset:57856
    ds_read_b64_tr_b16 v[108:109], v53 offset:59904
    ds_read_b64_tr_b16 v[110:111], v53 offset:61952
    v_pk_add_f32 v[18:19], v[8:9], v[10:11]
    v_lshlrev_b32 v82, 16, v65
    v_and_b32 v83, 0xffff0000, v65
    v_lshlrev_b32 v86, 16, v69
    v_and_b32 v87, 0xffff0000, v69
    v_add_f32 v17, v18, v19
    v_lshlrev_b32 v90, 16, v73
    v_and_b32 v91, 0xffff0000, v73
    v_lshlrev_b32 v94, 16, v77
    v_and_b32 v95, 0xffff0000, v77
    v_add_f32_dpp v17, v17, v17 row_ror:8 row_mask:0xf bank_mask:0xf
    v_pk_mul_f32 v[20:21], v[8:9], v[80:81] op_sel:[0,0] op_sel_hi:[0,1]
    v_pk_mul_f32 v[22:23], v[8:9], v[82:83] op_sel:[0,0] op_sel_hi:[0,1]
    v_rcp_f32 v18, v17
    v_pk_fma_f32 v[20:21], v[8:9], v[84:85], v[20:21] op_sel:[1,0,0] op_sel_hi:[1,1,1]
    v_pk_fma_f32 v[22:23], v[8:9], v[86:87], v[22:23] op_sel:[1,0,0] op_sel_hi:[1,1,1]
    v_pk_fma_f32 v[20:21], v[10:11], v[88:89], v[20:21] op_sel:[0,0,0] op_sel_hi:[0,1,1]
    v_pk_fma_f32 v[22:23], v[10:11], v[90:91], v[22:23] op_sel:[0,0,0] op_sel_hi:[0,1,1]
    v_pk_fma_f32 v[20:21], v[10:11], v[92:93], v[20:21] op_sel:[1,0,0] op_sel_hi:[1,1,1]
    v_pk_fma_f32 v[22:23], v[10:11], v[94:95], v[22:23] op_sel:[1,0,0] op_sel_hi:[1,1,1]
    s_nop 0
    v_add_f32_dpp v20, v20, v20 row_ror:8 row_mask:0xf bank_mask:0xf
    v_add_f32_dpp v21, v21, v21 row_ror:8 row_mask:0xf bank_mask:0xf
    v_add_f32_dpp v22, v22, v22 row_ror:8 row_mask:0xf bank_mask:0xf
    v_add_f32_dpp v23, v23, v23 row_ror:8 row_mask:0xf bank_mask:0xf
    v_pk_mul_f32 v[20:21], v[18:19], v[20:21] op_sel:[0,0] op_sel_hi:[0,1]
    v_pk_mul_f32 v[22:23], v[18:19], v[22:23] op_sel:[0,0] op_sel_hi:[0,1]
    v_cvt_pk_bf16_f32 v24, v20, v21
    v_cvt_pk_bf16_f32 v25, v22, v23
    ds_write_b64 v52, v[24:25] offset:4864
    ds_add_u32 v134, v1 offset:1536
    s_mov_b32 s51, 64
L_w48:
    ds_read_b32 v7, v2 offset:1536
    ds_read_b128 v[64:67], v54 offset:4864
    ds_read_b128 v[68:71], v54 offset:4928
    ds_read_b128 v[72:75], v54 offset:4992
    ds_read_b128 v[76:79], v54 offset:5056
    s_waitcnt lgkmcnt(0)
    v_cmp_le_u32 vcc, 4, v7
    s_cbranch_vccnz L_d49
    s_cmp_eq_u32 s36, 0
    s_cbranch_scc1 L_d49
    s_sub_u32 s36, s36, 1
    s_sub_u32 s51, s51, 1
    s_cbranch_scc1 L_r50
    s_branch L_w48
L_d49:
    v_cmp_gt_u32 vcc, 112, v63
    s_cbranch_vccnz L_B_wo
L_B_wod:
    v_mfma_f32_16x16x32_bf16 v[112:115], v[96:99], v[64:67], 0
    v_mfma_f32_16x16x32_bf16 v[112:115], v[100:103], v[68:71], v[112:115]
    v_mfma_f32_16x16x32_bf16 v[112:115], v[104:107], v[72:75], v[112:115]
    v_mfma_f32_16x16x32_bf16 v[112:115], v[108:111], v[76:79], v[112:115]
    ds_read_b32 v60, v2 offset:2048
    s_nop 6
    v_perm_b32 v8, v112, v59, s44
    v_perm_b32 v9, v113, v59, s45
    v_perm_b32 v10, v114, v59, s46
    v_perm_b32 v11, v115, v59, s47
    s_mov_b64 exec, s[12:13]
    global_store_dwordx4 v55, v[8:11], s[28:29] sc1
    s_mov_b64 exec, -1
    s_waitcnt lgkmcnt(0)
    v_cmp_eq_u32 vcc, 0, v60
    s_cbranch_vccnz L_fin
L_B_far:
    ds_add_u32 v134, v1 offset:2048
    s_mov_b64 exec, s[6:7]
    global_store_dwordx4 v132, v[128:131], s[28:29] sc1
    s_mov_b64 exec, s[10:11]
    global_store_dwordx4 v50, v[56:59], s[28:29] sc1
    s_mov_b64 exec, -1
    s_branch L_fin
L_r36:
    ds_add_u32 v134, v1 offset:2048
    s_mov_b64 exec, s[6:7]
    global_store_dwordx4 v132, v[128:131], s[28:29] sc1
    s_mov_b64 exec, -1
    s_branch L_w34
L_r47:
    ds_add_u32 v134, v1 offset:2048
    s_mov_b64 exec, s[6:7]
    global_store_dwordx4 v132, v[128:131], s[28:29] sc1
    s_mov_b64 exec, s[10:11]
    global_store_dwordx4 v50, v[56:59], s[28:29] sc1
    s_mov_b64 exec, -1
    s_branch L_B_og
L_r50:
    ds_add_u32 v134, v1 offset:2048
    s_mov_b64 exec, s[6:7]
    global_store_dwordx4 v132, v[128:131], s[28:29] sc1
    s_mov_b64 exec, s[10:11]
    global_store_dwordx4 v50, v[56:59], s[28:29] sc1
    s_mov_b64 exec, -1
    s_branch L_w48
L_B_wo:
L_w51:
    ds_read_b32 v7, v2 offset:0
    ds_read_b64_tr_b16 v[96:97], v53 offset:47616
    ds_read_b64_tr_b16 v[98:99], v53 offset:49664
    ds_read_b64_tr_b16 v[100:101], v53 offset:51712
    ds_read_b64_tr_b16 v[102:103], v53 offset:53760
    ds_read_b64_tr_b16 v[104:105], v53 offset:55808
    ds_read_b64_tr_b16 v[106:107], v53 offset:57856
    ds_read_b64_tr_b16 v[108:109], v53 offset:59904
    ds_read_b64_tr_b16 v[110:111], v53 offset:61952
    s_waitcnt lgkmcnt(0)
    v_cmp_le_u32 vcc, 112, v7
    s_cbranch_vccnz L_d52
    s_cmp_eq_u32 s36, 0
    s_cbranch_scc1 L_d52
    s_sub_u32 s36, s36, 1
    s_branch L_w51
L_d52:
    s_branch L_B_wod
L_fin:
L_end:
    s_endpgm
.fill 64, 4, 0xbf810000
.section .rodata,"a"
.p2align 6
.amdhsa_kernel recurrent_scan__sliding_block_cached__mixer_channel_mlp__decode_kernel
  .amdhsa_next_free_vgpr 144
  .amdhsa_next_free_sgpr 96
  .amdhsa_accum_offset 144
  .amdhsa_group_segment_fixed_size 0
  .amdhsa_kernarg_size 104
  .amdhsa_user_sgpr_count 2
  .amdhsa_user_sgpr_kernarg_segment_ptr 1
  .amdhsa_system_sgpr_workgroup_id_x 1
  .amdhsa_float_denorm_mode_32 3
.end_amdhsa_kernel
```
